```python
import torch

def _softmax(x, axis=-1):
    return torch.softmax(x, dim=axis)
def _gelu(x):
    return torch.nn.functional.gelu(x, approximate="tanh")
def _silu(x):
    return torch.nn.functional.silu(x)
def _sigmoid(x):
    return torch.sigmoid(x)
def _layernorm(x, axis=-1, eps=1e-5):
    m = x.mean(dim=axis, keepdim=True)
    v = x.var(dim=axis, keepdim=True, unbiased=False)
    return (x - m) / torch.sqrt(v + eps)
def _scatter_add(tgt, idx, src, axis=0):
    return tgt.clone().index_add_(axis, idx, src)
def _segment_sum(src, seg, n):
    out = torch.zeros((n,) + src.shape[1:], dtype=src.dtype)
    return out.index_add_(0, seg, src)
def _pad(x, pw):
    flat = tuple(v for pair in reversed(pw) for v in pair)
    return torch.nn.functional.pad(x, flat)

kernel_name = 'parallel_sum__gqa_block_cached__swiglu_ffn__decode'

def setup_inputs():

    _w = (lambda a: (lambda t: t.to(torch.bfloat16) if t.is_floating_point() else t)(torch.as_tensor(a)))
    def _A_setup():
        B, Sq, D = 2, 1, 576
        Hq, Hkv, Sk, Dh = 32, 16, 4096, 128
        assert Hq % Hkv == 0, (Hq, Hkv)
        return {
            "x": _w((lambda *s: torch.randn(*s, dtype=torch.bfloat16) * 0.05)(B, Sq, D)),
            "k_cache": _w((lambda *s: torch.randn(*s, dtype=torch.bfloat16) * 3.2)(B, Hkv, Sk, Dh)),
            "v_cache": _w((lambda *s: torch.randn(*s, dtype=torch.bfloat16) * 1.6)(B, Hkv, Sk, Dh)),
            "wq": _w((lambda *s: torch.randn(*s, dtype=torch.bfloat16) * 3.2)(D, Hq * Dh) * (D ** -0.5)),
            "wo": _w((lambda *s: torch.randn(*s, dtype=torch.bfloat16) * 1.6)(Hq * Dh, D) * ((Hq * Dh) ** -0.5)),
        }
    _A_in = _A_setup()

    def _B_setup():
        B, S, D, F = 2, 1, 576, 4608
        return {
            "x": _w((lambda *s: torch.randn(*s, dtype=torch.bfloat16) * 0.05)(B, S, D)),
            "w_gate": _w((lambda *s: torch.randn(*s, dtype=torch.bfloat16) * 0.05)(D, F)),
            "w_up": _w((lambda *s: torch.randn(*s, dtype=torch.bfloat16) * 0.05)(D, F)),
            "w_down": _w((lambda *s: torch.randn(*s, dtype=torch.bfloat16) * 0.05)(F, D)),
        }
    _B_in = _B_setup()

    return {
        "A_x": _A_in["x"],
        "A_k_cache": _A_in["k_cache"],
        "A_v_cache": _A_in["v_cache"],
        "A_wq": _A_in["wq"],
        "A_wo": _A_in["wo"],
        "B_x": _B_in["x"],
        "B_w_gate": _B_in["w_gate"],
        "B_w_up": _B_in["w_up"],
        "B_w_down": _B_in["w_down"],
    }

def reference(A_x, A_k_cache, A_v_cache, A_wq, A_wo, B_x, B_w_gate, B_w_up, B_w_down):
    def _A_ref(x, k_cache, v_cache, wq, wo):
        B, Sq, D = x.shape
        Hq, Dh = 32, 128
        Hkv = k_cache.shape[1]
        rep = Hq // Hkv
        q = (lambda x, *d: x.permute(*d))((x @ wq).reshape(B, Sq, Hq, Dh), 0, 2, 1, 3)
        k = (lambda x, n, axis: torch.repeat_interleave(x, n, dim=axis))(k_cache, rep, axis=1)
        v = (lambda x, n, axis: torch.repeat_interleave(x, n, dim=axis))(v_cache, rep, axis=1)
        scores = torch.einsum("bhqd,bhkd->bhqk", q, k) * (Dh ** -0.5)
        p = _softmax(scores, axis=-1)
        o = torch.einsum("bhqk,bhkd->bhqd", p, v)
        return (lambda x, *d: x.permute(*d))(o, 0, 2, 1, 3).reshape(B, Sq, Hq * Dh) @ wo

    def _B_ref(x, w_gate, w_up, w_down):
        g = _silu(x @ w_gate)
        u = x @ w_up
        return (g * u) @ w_down

    x = A_x
    xn = _layernorm(x, axis=-1)
    return x + _A_ref(xn, A_k_cache, A_v_cache, A_wq, A_wo) + _B_ref(xn, B_w_gate, B_w_up, B_w_down)
```

```asm
; @launch grid=(256,1,1) block=(768,1,1) lds=37888
.amdgcn_target "amdgcn-amd-amdhsa--gfx950"
.text
.globl parallel_sum__gqa_block_cached__swiglu_ffn__decode_kernel
.p2align 8
.type parallel_sum__gqa_block_cached__swiglu_ffn__decode_kernel,@function
parallel_sum__gqa_block_cached__swiglu_ffn__decode_kernel:
  s_cmp_ge_u32 s2, 256
  s_cbranch_scc1 L_end
  s_load_dwordx16 s[4:19], s[0:1], 0
  s_load_dwordx8 s[20:27], s[0:1], 64
  v_lshrrev_b32 v3, 6, v0
  v_and_b32 v0, 63, v0
  v_readfirstlane_b32 s28, v3
  v_and_b32 v1, 15, v0
  v_lshrrev_b32 v2, 4, v0
  s_and_b32 s29, s2, 7
  s_lshr_b32 s30, s2, 3
  s_lshr_b32 s56, s30, 4
  s_lshl_b32 s31, s29, 1
  s_add_u32 s56, s56, s31
  s_bfe_u32 s57, s30, 0x10003
  s_and_b32 s58, s30, 7
  s_mov_b32 s61, 0x3fb8aa3b
  s_mov_b32 s90, 18
  s_mul_i32 s91, s29, 18
  s_mov_b32 s41, 0x07060500
  s_mov_b32 s42, 0x07060501
  s_mov_b32 s43, 0x07060502
  s_mov_b32 s44, 0x07060503
  s_mov_b32 s45, 0x0c0c0400
  s_mov_b32 s46, 0x04000c0c
  s_cmp_ge_u32 s28, 4
  s_cbranch_scc1 L_attn
  s_setprio 3
  s_cmp_lg_u32 s28, 0
  s_cbranch_scc1 L_noinit
  v_lshlrev_b32 v3, 4, v0
  v_mov_b32 v4, 0
  v_mov_b32 v5, 0
  v_mov_b32 v6, 0
  v_mov_b32 v7, 0
  ds_write_b128 v3, v[4:7]
L_noinit:
  s_cmp_ge_u32 s30, 26
  s_cbranch_scc1 L_roleO
  v_lshrrev_b32 v3, 5, v0
  v_and_b32 v4, 31, v0
  v_mul_u32_u24 v3, 1152, v3
  v_mad_u32_u24 v3, v4, 36, v3
  v_mov_b32 v15, v3
  s_cmp_ge_u32 s30, 18
  s_cbranch_scc1 L_tileLight
  s_mul_i32 s47, s29, 18
  s_add_u32 s47, s47, s30
  s_and_b32 s48, s47, 1
  s_lshr_b32 s31, s47, 1
  s_branch L_tileCT
L_tileLight:
  s_sub_u32 s32, s30, 18
  s_and_b32 s48, s32, 1
  s_lshl_b32 s31, s29, 3
  s_add_u32 s31, s31, s32
  s_lshr_b32 s31, s31, 1
  s_add_u32 s31, s31, 72
L_tileCT:
  s_lshl_b32 s55, s31, 1
  s_add_u32 s55, s55, s48
  s_mov_b32 s94, s31
  s_mov_b32 s54, 9216
  s_mov_b32 s32, 0
  s_cmp_ge_u32 s31, 36
  s_cselect_b32 s32, 36, s32
  s_cmp_ge_u32 s31, 72
  s_cselect_b32 s32, 72, s32
  s_cselect_b32 s54, 8192, s54
  s_sub_u32 s31, s31, s32
  s_mul_i32 s32, s48, 288
  s_mul_i32 s33, s28, 72
  s_add_u32 s48, s32, s33
  s_mul_i32 s32, s48, s54
  s_lshl_b32 s31, s31, 8
  s_add_u32 s32, s32, s31
  v_mul_lo_u32 v3, v2, s54
  v_lshl_add_u32 v3, v1, 4, v3
  s_lshl_b32 s54, s54, 2
  s_mov_b32 s95, s32
  s_waitcnt lgkmcnt(0)
  s_cmp_lg_u32 s28, 1
  s_cbranch_scc1 L_nogen
  s_load_dword s40, s[26:27], 0
L_nogen:
  global_load_dwordx4 v[124:127], v15, s[4:5]
  global_load_dwordx4 v[128:131], v15, s[4:5] offset:16
  global_load_dword v132, v15, s[4:5] offset:32
  s_mov_b64 s[36:37], s[16:17]
  s_cmp_ge_u32 s94, 36
  s_cselect_b64 s[36:37], s[18:19], s[36:37]
  s_cmp_ge_u32 s94, 72
  s_cselect_b64 s[36:37], s[10:11], s[36:37]
  s_add_u32 s36, s36, s95
  s_addc_u32 s37, s37, 0
  global_load_dwordx4 v[16:19], v3, s[36:37] nt
  s_add_u32 s36, s36, s54
  s_addc_u32 s37, s37, 0
  global_load_dwordx4 v[20:23], v3, s[36:37] nt
  s_add_u32 s36, s36, s54
  s_addc_u32 s37, s37, 0
  global_load_dwordx4 v[24:27], v3, s[36:37] nt
  s_add_u32 s36, s36, s54
  s_addc_u32 s37, s37, 0
  global_load_dwordx4 v[28:31], v3, s[36:37] nt
  s_add_u32 s36, s36, s54
  s_addc_u32 s37, s37, 0
  global_load_dwordx4 v[32:35], v3, s[36:37] nt
  s_add_u32 s36, s36, s54
  s_addc_u32 s37, s37, 0
  global_load_dwordx4 v[36:39], v3, s[36:37] nt
  s_add_u32 s36, s36, s54
  s_addc_u32 s37, s37, 0
  global_load_dwordx4 v[40:43], v3, s[36:37] nt
  s_add_u32 s36, s36, s54
  s_addc_u32 s37, s37, 0
  global_load_dwordx4 v[44:47], v3, s[36:37] nt
  s_add_u32 s36, s36, s54
  s_addc_u32 s37, s37, 0
  global_load_dwordx4 v[48:51], v3, s[36:37] nt
  s_add_u32 s36, s36, s54
  s_addc_u32 s37, s37, 0
  global_load_dwordx4 v[52:55], v3, s[36:37] nt
  s_add_u32 s36, s36, s54
  s_addc_u32 s37, s37, 0
  global_load_dwordx4 v[56:59], v3, s[36:37] nt
  s_add_u32 s36, s36, s54
  s_addc_u32 s37, s37, 0
  global_load_dwordx4 v[60:63], v3, s[36:37] nt
  s_add_u32 s36, s36, s54
  s_addc_u32 s37, s37, 0
  global_load_dwordx4 v[64:67], v3, s[36:37] nt
  s_add_u32 s36, s36, s54
  s_addc_u32 s37, s37, 0
  global_load_dwordx4 v[68:71], v3, s[36:37] nt
  s_add_u32 s36, s36, s54
  s_addc_u32 s37, s37, 0
  global_load_dwordx4 v[72:75], v3, s[36:37] nt
  s_add_u32 s36, s36, s54
  s_addc_u32 s37, s37, 0
  global_load_dwordx4 v[76:79], v3, s[36:37] nt
  s_add_u32 s36, s36, s54
  s_addc_u32 s37, s37, 0
  global_load_dwordx4 v[80:83], v3, s[36:37] nt
  s_add_u32 s36, s36, s54
  s_addc_u32 s37, s37, 0
  global_load_dwordx4 v[84:87], v3, s[36:37] nt
  s_barrier
  s_cmp_lg_u32 s28, 1
  s_cbranch_scc1 L_notag1
  s_waitcnt lgkmcnt(0)
  s_add_u32 s40, s40, 1
  s_and_b32 s31, s40, 0xff
  s_mul_i32 s31, s31, 0x01010100
  s_mov_b32 s32, s40
  s_xor_b32 s40, s40, s31
  v_mov_b32 v4, 0
  v_mov_b32 v5, s40
  v_mov_b32 v6, s32
  ds_write_b32 v4, v5 offset:4
  ds_write_b32 v4, v6 offset:28
  s_waitcnt lgkmcnt(0)
  v_mov_b32 v5, 1
  ds_write_b32 v4, v5 offset:0
L_notag1:
  s_waitcnt vmcnt(18)
  v_lshlrev_b32 v136, 16, v124
  v_and_b32 v137, 0xffff0000, v124
  v_lshlrev_b32 v138, 16, v125
  v_and_b32 v139, 0xffff0000, v125
  v_lshlrev_b32 v140, 16, v126
  v_and_b32 v141, 0xffff0000, v126
  v_lshlrev_b32 v142, 16, v127
  v_and_b32 v143, 0xffff0000, v127
  v_lshlrev_b32 v144, 16, v128
  v_and_b32 v145, 0xffff0000, v128
  v_lshlrev_b32 v146, 16, v129
  v_and_b32 v147, 0xffff0000, v129
  v_lshlrev_b32 v148, 16, v130
  v_and_b32 v149, 0xffff0000, v130
  v_lshlrev_b32 v150, 16, v131
  v_and_b32 v151, 0xffff0000, v131
  v_lshlrev_b32 v152, 16, v132
  v_and_b32 v153, 0xffff0000, v132
  v_add_f32 v154, v136, v137
  v_add_f32 v154, v154, v138
  v_add_f32 v154, v154, v139
  v_add_f32 v154, v154, v140
  v_add_f32 v154, v154, v141
  v_add_f32 v154, v154, v142
  v_add_f32 v154, v154, v143
  v_add_f32 v154, v154, v144
  v_add_f32 v154, v154, v145
  v_add_f32 v154, v154, v146
  v_add_f32 v154, v154, v147
  v_add_f32 v154, v154, v148
  v_add_f32 v154, v154, v149
  v_add_f32 v154, v154, v150
  v_add_f32 v154, v154, v151
  v_add_f32 v154, v154, v152
  v_add_f32 v154, v154, v153
  s_nop 1
  v_add_f32_dpp v154, v154, v154 row_ror:8 row_mask:0xf bank_mask:0xf
  s_nop 1
  v_add_f32_dpp v154, v154, v154 row_ror:4 row_mask:0xf bank_mask:0xf
  s_nop 1
  v_add_f32_dpp v154, v154, v154 row_ror:2 row_mask:0xf bank_mask:0xf
  s_nop 1
  v_add_f32_dpp v154, v154, v154 row_ror:1 row_mask:0xf bank_mask:0xf
  v_mov_b32 v155, v154
  s_nop 1
  v_permlane16_swap_b32 v154, v155
  s_nop 0
  v_add_f32 v154, v154, v155
  v_mul_f32 v154, 0x3ae38e39, v154
  v_sub_f32 v157, v136, v154
  v_mul_f32 v156, v157, v157
  v_sub_f32 v157, v137, v154
  v_fmac_f32 v156, v157, v157
  v_sub_f32 v157, v138, v154
  v_fmac_f32 v156, v157, v157
  v_sub_f32 v157, v139, v154
  v_fmac_f32 v156, v157, v157
  v_sub_f32 v157, v140, v154
  v_fmac_f32 v156, v157, v157
  v_sub_f32 v157, v141, v154
  v_fmac_f32 v156, v157, v157
  v_sub_f32 v157, v142, v154
  v_fmac_f32 v156, v157, v157
  v_sub_f32 v157, v143, v154
  v_fmac_f32 v156, v157, v157
  v_sub_f32 v157, v144, v154
  v_fmac_f32 v156, v157, v157
  v_sub_f32 v157, v145, v154
  v_fmac_f32 v156, v157, v157
  v_sub_f32 v157, v146, v154
  v_fmac_f32 v156, v157, v157
  v_sub_f32 v157, v147, v154
  v_fmac_f32 v156, v157, v157
  v_sub_f32 v157, v148, v154
  v_fmac_f32 v156, v157, v157
  v_sub_f32 v157, v149, v154
  v_fmac_f32 v156, v157, v157
  v_sub_f32 v157, v150, v154
  v_fmac_f32 v156, v157, v157
  v_sub_f32 v157, v151, v154
  v_fmac_f32 v156, v157, v157
  v_sub_f32 v157, v152, v154
  v_fmac_f32 v156, v157, v157
  v_sub_f32 v157, v153, v154
  v_fmac_f32 v156, v157, v157
  s_nop 1
  v_add_f32_dpp v156, v156, v156 row_ror:8 row_mask:0xf bank_mask:0xf
  s_nop 1
  v_add_f32_dpp v156, v156, v156 row_ror:4 row_mask:0xf bank_mask:0xf
  s_nop 1
  v_add_f32_dpp v156, v156, v156 row_ror:2 row_mask:0xf bank_mask:0xf
  s_nop 1
  v_add_f32_dpp v156, v156, v156 row_ror:1 row_mask:0xf bank_mask:0xf
  v_mov_b32 v155, v156
  s_nop 1
  v_permlane16_swap_b32 v156, v155
  s_nop 0
  v_add_f32 v156, v156, v155
  v_mul_f32 v156, 0x3ae38e39, v156
  v_cvt_pk_bf16_f32 v156, v156, v156
  v_and_b32 v156, 0xffff0000, v156
  v_add_f32 v156, 0x3727c5ac, v156
  v_cvt_pk_bf16_f32 v156, v156, v156
  v_and_b32 v156, 0xffff0000, v156
  v_sqrt_f32 v156, v156
  s_nop 0
  v_cvt_pk_bf16_f32 v156, v156, v156
  v_and_b32 v156, 0xffff0000, v156
  v_rcp_f32 v156, v156
  v_cvt_pk_bf16_f32 v154, v154, v154
  v_and_b32 v154, 0xffff0000, v154
  v_sub_f32 v136, v136, v154
  v_sub_f32 v137, v137, v154
  v_sub_f32 v138, v138, v154
  v_sub_f32 v139, v139, v154
  v_sub_f32 v140, v140, v154
  v_sub_f32 v141, v141, v154
  v_sub_f32 v142, v142, v154
  v_sub_f32 v143, v143, v154
  v_sub_f32 v144, v144, v154
  v_sub_f32 v145, v145, v154
  v_sub_f32 v146, v146, v154
  v_sub_f32 v147, v147, v154
  v_sub_f32 v148, v148, v154
  v_sub_f32 v149, v149, v154
  v_sub_f32 v150, v150, v154
  v_sub_f32 v151, v151, v154
  v_sub_f32 v152, v152, v154
  v_sub_f32 v153, v153, v154
  v_cvt_pk_bf16_f32 v124, v136, v137
  v_cvt_pk_bf16_f32 v125, v138, v139
  v_cvt_pk_bf16_f32 v126, v140, v141
  v_cvt_pk_bf16_f32 v127, v142, v143
  v_cvt_pk_bf16_f32 v128, v144, v145
  v_cvt_pk_bf16_f32 v129, v146, v147
  v_cvt_pk_bf16_f32 v130, v148, v149
  v_cvt_pk_bf16_f32 v131, v150, v151
  v_cvt_pk_bf16_f32 v132, v152, v153
  v_lshlrev_b32 v136, 16, v124
  v_and_b32 v137, 0xffff0000, v124
  v_lshlrev_b32 v138, 16, v125
  v_and_b32 v139, 0xffff0000, v125
  v_lshlrev_b32 v140, 16, v126
  v_and_b32 v141, 0xffff0000, v126
  v_lshlrev_b32 v142, 16, v127
  v_and_b32 v143, 0xffff0000, v127
  v_lshlrev_b32 v144, 16, v128
  v_and_b32 v145, 0xffff0000, v128
  v_lshlrev_b32 v146, 16, v129
  v_and_b32 v147, 0xffff0000, v129
  v_lshlrev_b32 v148, 16, v130
  v_and_b32 v149, 0xffff0000, v130
  v_lshlrev_b32 v150, 16, v131
  v_and_b32 v151, 0xffff0000, v131
  v_lshlrev_b32 v152, 16, v132
  v_and_b32 v153, 0xffff0000, v132
  v_mul_f32 v136, v136, v156
  v_mul_f32 v137, v137, v156
  v_mul_f32 v138, v138, v156
  v_mul_f32 v139, v139, v156
  v_mul_f32 v140, v140, v156
  v_mul_f32 v141, v141, v156
  v_mul_f32 v142, v142, v156
  v_mul_f32 v143, v143, v156
  v_mul_f32 v144, v144, v156
  v_mul_f32 v145, v145, v156
  v_mul_f32 v146, v146, v156
  v_mul_f32 v147, v147, v156
  v_mul_f32 v148, v148, v156
  v_mul_f32 v149, v149, v156
  v_mul_f32 v150, v150, v156
  v_mul_f32 v151, v151, v156
  v_mul_f32 v152, v152, v156
  v_mul_f32 v153, v153, v156
  v_cvt_pk_bf16_f32 v136, v136, v136
  v_cvt_pk_bf16_f32 v137, v137, v137
  v_cvt_pk_bf16_f32 v138, v138, v138
  v_cvt_pk_bf16_f32 v139, v139, v139
  v_cvt_pk_bf16_f32 v140, v140, v140
  v_cvt_pk_bf16_f32 v141, v141, v141
  v_cvt_pk_bf16_f32 v142, v142, v142
  v_cvt_pk_bf16_f32 v143, v143, v143
  v_cvt_pk_bf16_f32 v144, v144, v144
  v_cvt_pk_bf16_f32 v145, v145, v145
  v_cvt_pk_bf16_f32 v146, v146, v146
  v_cvt_pk_bf16_f32 v147, v147, v147
  v_cvt_pk_bf16_f32 v148, v148, v148
  v_cvt_pk_bf16_f32 v149, v149, v149
  v_cvt_pk_bf16_f32 v150, v150, v150
  v_cvt_pk_bf16_f32 v151, v151, v151
  v_cvt_pk_bf16_f32 v152, v152, v152
  v_cvt_pk_bf16_f32 v153, v153, v153
  v_lshrrev_b32 v3, 5, v0
  v_and_b32 v4, 31, v0
  v_mul_u32_u24 v3, 576, v3
  v_mad_u32_u24 v3, v4, 18, v3
  v_lshlrev_b32 v3, 2, v3
  ds_write_b64 v3, v[136:137] offset:5120
  ds_write_b64 v3, v[138:139] offset:5128
  ds_write_b64 v3, v[140:141] offset:5136
  ds_write_b64 v3, v[142:143] offset:5144
  ds_write_b64 v3, v[144:145] offset:5152
  ds_write_b64 v3, v[146:147] offset:5160
  ds_write_b64 v3, v[148:149] offset:5168
  ds_write_b64 v3, v[150:151] offset:5176
  ds_write_b64 v3, v[152:153] offset:5184
  s_waitcnt lgkmcnt(0)
  v_and_b32 v12, 7, v1
  v_and_b32 v13, 1, v12
  v_lshrrev_b32 v12, 1, v12
  v_mov_b32 v14, 0xffff
  v_lshlrev_b32 v13, 4, v13
  v_lshlrev_b32 v13, v13, v14
  v_cmp_eq_u32_e32 vcc, 0, v12
  s_nop 1
  v_cndmask_b32_e32 v8, 0, v13, vcc
  v_cmp_eq_u32_e32 vcc, 1, v12
  s_nop 1
  v_cndmask_b32_e32 v9, 0, v13, vcc
  v_cmp_eq_u32_e32 vcc, 2, v12
  s_nop 1
  v_cndmask_b32_e32 v10, 0, v13, vcc
  v_cmp_eq_u32_e32 vcc, 3, v12
  s_nop 1
  v_cndmask_b32_e32 v11, 0, v13, vcc
  v_lshrrev_b32 v3, 3, v1
  v_mul_u32_u24 v3, 576, v3
  v_add_u32 v3, v3, v2
  v_add_u32 v3, s48, v3
  v_lshlrev_b32 v3, 2, v3
  ds_read_b32 v136, v3 offset:5120
  ds_read_b32 v137, v3 offset:5136
  ds_read_b32 v138, v3 offset:5152
  ds_read_b32 v139, v3 offset:5168
  ds_read_b32 v140, v3 offset:5184
  ds_read_b32 v141, v3 offset:5200
  ds_read_b32 v142, v3 offset:5216
  ds_read_b32 v143, v3 offset:5232
  ds_read_b32 v144, v3 offset:5248
  ds_read_b32 v145, v3 offset:5264
  ds_read_b32 v146, v3 offset:5280
  ds_read_b32 v147, v3 offset:5296
  ds_read_b32 v148, v3 offset:5312
  ds_read_b32 v149, v3 offset:5328
  ds_read_b32 v150, v3 offset:5344
  ds_read_b32 v151, v3 offset:5360
  ds_read_b32 v152, v3 offset:5376
  ds_read_b32 v153, v3 offset:5392
  v_mov_b32 v156, 0
  v_mov_b32 v157, 0
  v_mov_b32 v158, 0
  v_mov_b32 v159, 0
  s_waitcnt lgkmcnt(0)
  v_and_b32 v160, v136, v8
  v_and_b32 v161, v136, v9
  v_and_b32 v162, v136, v10
  v_and_b32 v163, v136, v11
  s_waitcnt vmcnt(17)
  s_nop 0
  v_mfma_f32_16x16x32_bf16 v[156:159], v[16:19], v[160:163], v[156:159]
  v_and_b32 v164, v137, v8
  v_and_b32 v165, v137, v9
  v_and_b32 v166, v137, v10
  v_and_b32 v167, v137, v11
  s_waitcnt vmcnt(16)
  s_nop 0
  v_mfma_f32_16x16x32_bf16 v[156:159], v[20:23], v[164:167], v[156:159]
  v_and_b32 v160, v138, v8
  v_and_b32 v161, v138, v9
  v_and_b32 v162, v138, v10
  v_and_b32 v163, v138, v11
  s_waitcnt vmcnt(15)
  s_nop 0
  v_mfma_f32_16x16x32_bf16 v[156:159], v[24:27], v[160:163], v[156:159]
  v_and_b32 v164, v139, v8
  v_and_b32 v165, v139, v9
  v_and_b32 v166, v139, v10
  v_and_b32 v167, v139, v11
  s_waitcnt vmcnt(14)
  s_nop 0
  v_mfma_f32_16x16x32_bf16 v[156:159], v[28:31], v[164:167], v[156:159]
  v_and_b32 v160, v140, v8
  v_and_b32 v161, v140, v9
  v_and_b32 v162, v140, v10
  v_and_b32 v163, v140, v11
  s_waitcnt vmcnt(13)
  s_nop 0
  v_mfma_f32_16x16x32_bf16 v[156:159], v[32:35], v[160:163], v[156:159]
  v_and_b32 v164, v141, v8
  v_and_b32 v165, v141, v9
  v_and_b32 v166, v141, v10
  v_and_b32 v167, v141, v11
  s_waitcnt vmcnt(12)
  s_nop 0
  v_mfma_f32_16x16x32_bf16 v[156:159], v[36:39], v[164:167], v[156:159]
  v_and_b32 v160, v142, v8
  v_and_b32 v161, v142, v9
  v_and_b32 v162, v142, v10
  v_and_b32 v163, v142, v11
  s_waitcnt vmcnt(11)
  s_nop 0
  v_mfma_f32_16x16x32_bf16 v[156:159], v[40:43], v[160:163], v[156:159]
  v_and_b32 v164, v143, v8
  v_and_b32 v165, v143, v9
  v_and_b32 v166, v143, v10
  v_and_b32 v167, v143, v11
  s_waitcnt vmcnt(10)
  s_nop 0
  v_mfma_f32_16x16x32_bf16 v[156:159], v[44:47], v[164:167], v[156:159]
  v_and_b32 v160, v144, v8
  v_and_b32 v161, v144, v9
  v_and_b32 v162, v144, v10
  v_and_b32 v163, v144, v11
  s_waitcnt vmcnt(9)
  s_nop 0
  v_mfma_f32_16x16x32_bf16 v[156:159], v[48:51], v[160:163], v[156:159]
  v_and_b32 v164, v145, v8
  v_and_b32 v165, v145, v9
  v_and_b32 v166, v145, v10
  v_and_b32 v167, v145, v11
  s_waitcnt vmcnt(8)
  s_nop 0
  v_mfma_f32_16x16x32_bf16 v[156:159], v[52:55], v[164:167], v[156:159]
  v_and_b32 v160, v146, v8
  v_and_b32 v161, v146, v9
  v_and_b32 v162, v146, v10
  v_and_b32 v163, v146, v11
  s_waitcnt vmcnt(7)
  s_nop 0
  v_mfma_f32_16x16x32_bf16 v[156:159], v[56:59], v[160:163], v[156:159]
  v_and_b32 v164, v147, v8
  v_and_b32 v165, v147, v9
  v_and_b32 v166, v147, v10
  v_and_b32 v167, v147, v11
  s_waitcnt vmcnt(6)
  s_nop 0
  v_mfma_f32_16x16x32_bf16 v[156:159], v[60:63], v[164:167], v[156:159]
  v_and_b32 v160, v148, v8
  v_and_b32 v161, v148, v9
  v_and_b32 v162, v148, v10
  v_and_b32 v163, v148, v11
  s_waitcnt vmcnt(5)
  s_nop 0
  v_mfma_f32_16x16x32_bf16 v[156:159], v[64:67], v[160:163], v[156:159]
  v_and_b32 v164, v149, v8
  v_and_b32 v165, v149, v9
  v_and_b32 v166, v149, v10
  v_and_b32 v167, v149, v11
  s_waitcnt vmcnt(4)
  s_nop 0
  v_mfma_f32_16x16x32_bf16 v[156:159], v[68:71], v[164:167], v[156:159]
  v_and_b32 v160, v150, v8
  v_and_b32 v161, v150, v9
  v_and_b32 v162, v150, v10
  v_and_b32 v163, v150, v11
  s_waitcnt vmcnt(3)
  s_nop 0
  v_mfma_f32_16x16x32_bf16 v[156:159], v[72:75], v[160:163], v[156:159]
  v_and_b32 v164, v151, v8
  v_and_b32 v165, v151, v9
  v_and_b32 v166, v151, v10
  v_and_b32 v167, v151, v11
  s_waitcnt vmcnt(2)
  s_nop 0
  v_mfma_f32_16x16x32_bf16 v[156:159], v[76:79], v[164:167], v[156:159]
  v_and_b32 v160, v152, v8
  v_and_b32 v161, v152, v9
  v_and_b32 v162, v152, v10
  v_and_b32 v163, v152, v11
  s_waitcnt vmcnt(1)
  s_nop 0
  v_mfma_f32_16x16x32_bf16 v[156:159], v[80:83], v[160:163], v[156:159]
  v_and_b32 v164, v153, v8
  v_and_b32 v165, v153, v9
  v_and_b32 v166, v153, v10
  v_and_b32 v167, v153, v11
  s_waitcnt vmcnt(0)
  s_nop 0
  v_mfma_f32_16x16x32_bf16 v[156:159], v[84:87], v[164:167], v[156:159]
  s_mov_b32 s49, 1048576
  v_mov_b32 v12, 0
L_tag_lp_1:
  ds_read_b32 v13, v12 offset:0
  s_waitcnt lgkmcnt(0)
  v_readfirstlane_b32 s31, v13
  s_cmp_ge_u32 s31, 1
  s_cbranch_scc1 L_tag_ok_2
  s_sub_u32 s49, s49, 1
  s_cbranch_scc1 L_tag_ok_2
  s_sleep 2
  s_branch L_tag_lp_1
L_tag_ok_2:
  ds_read_b32 v14, v12 offset:4
  s_waitcnt lgkmcnt(0)
  v_readfirstlane_b32 s40, v14
  s_lshl_b32 s31, s28, 10
  v_lshlrev_b32 v3, 4, v0
  v_add_u32 v4, s31, v3
  ds_write_b128 v4, v[156:159] offset:33792
  s_waitcnt lgkmcnt(0)
  v_mov_b32 v12, 0
  v_mov_b32 v13, 1
  s_mov_b64 s[52:53], exec
  s_mov_b64 exec, 1
  ds_add_rtn_u32 v13, v12, v13 offset:32
  s_waitcnt lgkmcnt(0)
  v_readfirstlane_b32 s31, v13
  s_mov_b64 exec, s[52:53]
  s_cmp_lg_u32 s31, 3
  s_cbranch_scc1 L_l1pubdone
  v_lshlrev_b32 v3, 4, v0
  ds_read_b128 v[124:127], v3 offset:33792
  ds_read_b128 v[128:131], v3 offset:34816
  ds_read_b128 v[132:135], v3 offset:35840
  ds_read_b128 v[136:139], v3 offset:36864
  s_lshl_b32 s31, s55, 10
  s_add_u32 s31, s31, 4096
  s_mov_b64 s[36:37], s[26:27]
  s_add_u32 s36, s36, s31
  s_addc_u32 s37, s37, 0
  s_waitcnt lgkmcnt(0)
  v_add_f32 v124, v124, v128
  v_add_f32 v125, v125, v129
  v_add_f32 v126, v126, v130
  v_add_f32 v127, v127, v131
  v_add_f32 v124, v124, v132
  v_add_f32 v125, v125, v133
  v_add_f32 v126, v126, v134
  v_add_f32 v127, v127, v135
  v_add_f32 v124, v124, v136
  v_add_f32 v125, v125, v137
  v_add_f32 v126, v126, v138
  v_add_f32 v127, v127, v139
  v_perm_b32 v160, v124, v14, s41
  v_perm_b32 v161, v125, v14, s42
  v_perm_b32 v162, v126, v14, s43
  v_perm_b32 v163, v127, v14, s44
  v_add_u32 v4, 3796992, v3
  s_cmp_lt_u32 s55, 144
  s_cbranch_scc1 L_noqalt
  global_store_dwordx4 v4, v[160:163], s[36:37]
L_noqalt:
  global_store_dwordx4 v3, v[160:163], s[36:37] sc1
L_l1pubdone:
  s_cmp_lg_u32 s28, 1
  s_cbranch_scc1 L_noq1
  s_lshl_b32 s31, s56, 12
  s_lshl_b32 s32, s57, 7
  s_add_u32 s31, s31, s32
  s_add_u32 s31, s31, 151552
  s_mov_b64 s[38:39], s[26:27]
  s_add_u32 s38, s38, s31
  s_addc_u32 s39, s39, 0
  v_lshrrev_b32 v3, 5, v0
  v_lshlrev_b32 v3, 11, v3
  v_bfe_u32 v4, v0, 3, 2
  v_lshl_add_u32 v3, v4, 8, v3
  v_and_b32 v4, 7, v0
  v_lshl_add_u32 v3, v4, 4, v3
  v_add_u32 v156, 3796992, v3
  v_mov_b32 v157, v3
  s_mov_b32 s49, 131072
  s_mov_b32 s63, 3
L_q_lp_3:
  s_and_b32 s31, s49, 1
  s_cmp_eq_u32 s31, 1
  s_cselect_b64 vcc, -1, 0
  v_cndmask_b32_e32 v3, v156, v157, vcc
  s_bitcmp1_b32 s63, 0
  s_cbranch_scc0 L_sk_5
  global_load_dwordx4 v[124:127], v3, s[38:39] offset:0 sc1
L_sk_5:
  s_bitcmp1_b32 s63, 1
  s_cbranch_scc0 L_sk_6
  global_load_dwordx4 v[128:131], v3, s[38:39] offset:1024 sc1
L_sk_6:
  s_waitcnt vmcnt(0)
  s_bitcmp1_b32 s63, 0
  s_cbranch_scc0 L_sk_7
  v_perm_b32 v5, v125, v124, s45
  v_perm_b32 v6, v127, v126, s46
  v_or_b32 v5, v5, v6
  v_cmp_eq_u32_e64 s[50:51], s40, v5
  s_cmp_eq_u64 s[50:51], -1
  s_cbranch_scc0 L_sk_7
  s_bitset0_b32 s63, 0
L_sk_7:
  s_bitcmp1_b32 s63, 1
  s_cbranch_scc0 L_sk_8
  v_perm_b32 v5, v129, v128, s45
  v_perm_b32 v6, v131, v130, s46
  v_or_b32 v5, v5, v6
  v_cmp_eq_u32_e64 s[50:51], s40, v5
  s_cmp_eq_u64 s[50:51], -1
  s_cbranch_scc0 L_sk_8
  s_bitset0_b32 s63, 1
L_sk_8:
  s_cmp_eq_u32 s63, 0
  s_cbranch_scc1 L_q_ok_4
  s_sub_u32 s49, s49, 1
  s_cbranch_scc1 L_q_ok_4
  s_sleep 4
  s_branch L_q_lp_3
L_q_ok_4:
  v_and_b32 v124, 0xffffff00, v124
  v_and_b32 v125, 0xffffff00, v125
  v_and_b32 v126, 0xffffff00, v126
  v_and_b32 v127, 0xffffff00, v127
  v_and_b32 v128, 0xffffff00, v128
  v_and_b32 v129, 0xffffff00, v129
  v_and_b32 v130, 0xffffff00, v130
  v_and_b32 v131, 0xffffff00, v131
  v_add_f32 v124, v124, v128
  v_add_f32 v125, v125, v129
  v_add_f32 v126, v126, v130
  v_add_f32 v127, v127, v131
  v_cvt_pk_bf16_f32 v124, v124, v125
  v_cvt_pk_bf16_f32 v126, v126, v127
  v_lshrrev_b32 v3, 5, v0
  v_lshlrev_b32 v3, 8, v3
  v_bfe_u32 v4, v0, 3, 2
  v_lshl_add_u32 v3, v4, 6, v3
  v_and_b32 v4, 7, v0
  v_lshl_add_u32 v3, v4, 1, v3
  ds_write_b16 v3, v124 offset:9728
  ds_write_b16_d16_hi v3, v124 offset:9744
  ds_write_b16 v3, v126 offset:9760
  ds_write_b16_d16_hi v3, v126 offset:9776
  s_waitcnt lgkmcnt(0)
  v_mov_b32 v4, 0
  v_mov_b32 v5, 1
  ds_write_b32 v4, v5 offset:8
L_noq1:
  s_cmp_ge_u32 s30, s90
  s_cbranch_scc1 L_roleQtail
  s_add_u32 s33, s91, s30
  s_mul_i32 s55, s33, 171
  s_lshr_b32 s55, s55, 9
  s_mul_i32 s32, s55, 3
  s_sub_u32 s59, s33, s32
  s_cmp_lg_u32 s28, 0
  s_cbranch_scc1 L_noh
  s_mov_b32 s49, 1048576
  v_mov_b32 v12, 0
L_hv_lp_9:
  ds_read_b32 v13, v12 offset:36
  s_waitcnt lgkmcnt(0)
  v_readfirstlane_b32 s31, v13
  s_cmp_ge_u32 s31, 2
  s_cbranch_scc1 L_hv_ok_10
  s_sub_u32 s49, s49, 1
  s_cbranch_scc1 L_hv_ok_10
  s_sleep 8
  s_branch L_hv_lp_9
L_hv_ok_10:
  s_mul_i32 s33, s55, 3
  v_lshrrev_b32 v3, 5, v0
  v_mul_u32_u24 v3, 73728, v3
  v_bfe_u32 v4, v0, 4, 1
  v_lshl_add_u32 v3, v4, 10, v3
  v_lshl_add_u32 v3, v1, 4, v3
  s_add_u32 s31, s33, 0
  s_lshr_b32 s32, s31, 2
  s_lshl_b32 s32, s32, 11
  s_and_b32 s31, s31, 3
  s_lshl_b32 s31, s31, 8
  s_add_u32 s31, s31, s32
  v_add_u32 v156, s31, v3
  s_add_u32 s31, s33, 1
  s_lshr_b32 s32, s31, 2
  s_lshl_b32 s32, s32, 11
  s_and_b32 s31, s31, 3
  s_lshl_b32 s31, s31, 8
  s_add_u32 s31, s31, s32
  v_add_u32 v157, s31, v3
  s_add_u32 s31, s33, 2
  s_lshr_b32 s32, s31, 2
  s_lshl_b32 s32, s32, 11
  s_and_b32 s31, s31, 3
  s_lshl_b32 s31, s31, 8
  s_add_u32 s31, s31, s32
  v_add_u32 v158, s31, v3
  s_mov_b64 s[38:39], s[26:27]
  s_add_u32 s38, s38, 4096
  s_addc_u32 s39, s39, 0
  s_mov_b32 s49, 131072
  s_mov_b32 s63, 7
L_h_lp_11:
  s_bitcmp1_b32 s63, 0
  s_cbranch_scc0 L_sk_13
  global_load_dwordx4 v[124:127], v156, s[38:39] sc1
L_sk_13:
  s_bitcmp1_b32 s63, 1
  s_cbranch_scc0 L_sk_14
  global_load_dwordx4 v[128:131], v157, s[38:39] sc1
L_sk_14:
  s_bitcmp1_b32 s63, 2
  s_cbranch_scc0 L_sk_15
  global_load_dwordx4 v[132:135], v158, s[38:39] sc1
L_sk_15:
  s_waitcnt vmcnt(0)
  s_bitcmp1_b32 s63, 0
  s_cbranch_scc0 L_sk_16
  v_perm_b32 v5, v125, v124, s45
  v_perm_b32 v6, v127, v126, s46
  v_or_b32 v5, v5, v6
  v_cmp_eq_u32_e64 s[50:51], s40, v5
  s_cmp_eq_u64 s[50:51], -1
  s_cbranch_scc0 L_sk_16
  s_bitset0_b32 s63, 0
L_sk_16:
  s_bitcmp1_b32 s63, 1
  s_cbranch_scc0 L_sk_17
  v_perm_b32 v5, v129, v128, s45
  v_perm_b32 v6, v131, v130, s46
  v_or_b32 v5, v5, v6
  v_cmp_eq_u32_e64 s[50:51], s40, v5
  s_cmp_eq_u64 s[50:51], -1
  s_cbranch_scc0 L_sk_17
  s_bitset0_b32 s63, 1
L_sk_17:
  s_bitcmp1_b32 s63, 2
  s_cbranch_scc0 L_sk_18
  v_perm_b32 v5, v133, v132, s45
  v_perm_b32 v6, v135, v134, s46
  v_or_b32 v5, v5, v6
  v_cmp_eq_u32_e64 s[50:51], s40, v5
  s_cmp_eq_u64 s[50:51], -1
  s_cbranch_scc0 L_sk_18
  s_bitset0_b32 s63, 2
L_sk_18:
  s_cmp_eq_u32 s63, 0
  s_cbranch_scc1 L_h_ok_12
  s_sub_u32 s49, s49, 1
  s_cbranch_scc1 L_h_ok_12
  s_sleep 8
  s_branch L_h_lp_11
L_h_ok_12:
  v_and_b32 v124, 0xffffff00, v124
  v_and_b32 v125, 0xffffff00, v125
  v_and_b32 v126, 0xffffff00, v126
  v_and_b32 v127, 0xffffff00, v127
  v_and_b32 v128, 0xffffff00, v128
  v_and_b32 v129, 0xffffff00, v129
  v_and_b32 v130, 0xffffff00, v130
  v_and_b32 v131, 0xffffff00, v131
  v_and_b32 v132, 0xffffff00, v132
  v_and_b32 v133, 0xffffff00, v133
  v_and_b32 v134, 0xffffff00, v134
  v_and_b32 v135, 0xffffff00, v135
  v_mov_b32 v136, v124
  v_mov_b32 v137, v125
  v_mov_b32 v138, v126
  v_mov_b32 v139, v127
  v_mov_b32 v140, v128
  v_mov_b32 v141, v129
  v_mov_b32 v142, v130
  v_mov_b32 v143, v131
  v_mov_b32 v144, v132
  v_mov_b32 v145, v133
  v_mov_b32 v146, v134
  v_mov_b32 v147, v135
  s_nop 1
  v_permlane16_swap_b32 v124, v136
  v_permlane16_swap_b32 v125, v137
  v_permlane16_swap_b32 v126, v138
  v_permlane16_swap_b32 v127, v139
  v_permlane16_swap_b32 v128, v140
  v_permlane16_swap_b32 v129, v141
  v_permlane16_swap_b32 v130, v142
  v_permlane16_swap_b32 v131, v143
  v_permlane16_swap_b32 v132, v144
  v_permlane16_swap_b32 v133, v145
  v_permlane16_swap_b32 v134, v146
  v_permlane16_swap_b32 v135, v147
  s_nop 0
  v_add_f32 v124, v124, v136
  v_add_f32 v125, v125, v137
  v_add_f32 v126, v126, v138
  v_add_f32 v127, v127, v139
  v_add_f32 v128, v128, v140
  v_add_f32 v129, v129, v141
  v_add_f32 v130, v130, v142
  v_add_f32 v131, v131, v143
  v_add_f32 v132, v132, v144
  v_add_f32 v133, v133, v145
  v_add_f32 v134, v134, v146
  v_add_f32 v135, v135, v147
  v_cvt_pk_bf16_f32 v124, v124, v124
  v_and_b32 v124, 0xffff0000, v124
  v_cvt_pk_bf16_f32 v125, v125, v125
  v_and_b32 v125, 0xffff0000, v125
  v_cvt_pk_bf16_f32 v126, v126, v126
  v_and_b32 v126, 0xffff0000, v126
  v_cvt_pk_bf16_f32 v127, v127, v127
  v_and_b32 v127, 0xffff0000, v127
  v_cvt_pk_bf16_f32 v128, v128, v128
  v_and_b32 v128, 0xffff0000, v128
  v_cvt_pk_bf16_f32 v129, v129, v129
  v_and_b32 v129, 0xffff0000, v129
  v_cvt_pk_bf16_f32 v130, v130, v130
  v_and_b32 v130, 0xffff0000, v130
  v_cvt_pk_bf16_f32 v131, v131, v131
  v_and_b32 v131, 0xffff0000, v131
  v_cvt_pk_bf16_f32 v132, v132, v132
  v_and_b32 v132, 0xffff0000, v132
  v_cvt_pk_bf16_f32 v133, v133, v133
  v_and_b32 v133, 0xffff0000, v133
  v_cvt_pk_bf16_f32 v134, v134, v134
  v_and_b32 v134, 0xffff0000, v134
  v_cvt_pk_bf16_f32 v135, v135, v135
  v_and_b32 v135, 0xffff0000, v135
  v_mov_b32 v148, v124
  v_mov_b32 v149, v125
  v_mov_b32 v150, v126
  v_mov_b32 v151, v127
  v_mov_b32 v152, v128
  v_mov_b32 v153, v129
  v_mov_b32 v154, v130
  v_mov_b32 v155, v131
  v_mov_b32 v156, v132
  v_mov_b32 v157, v133
  v_mov_b32 v158, v134
  v_mov_b32 v159, v135
  s_nop 1
  v_permlane32_swap_b32 v124, v148
  v_permlane32_swap_b32 v125, v149
  v_permlane32_swap_b32 v126, v150
  v_permlane32_swap_b32 v127, v151
  v_permlane32_swap_b32 v128, v152
  v_permlane32_swap_b32 v129, v153
  v_permlane32_swap_b32 v130, v154
  v_permlane32_swap_b32 v131, v155
  v_permlane32_swap_b32 v132, v156
  v_permlane32_swap_b32 v133, v157
  v_permlane32_swap_b32 v134, v158
  v_permlane32_swap_b32 v135, v159
  s_nop 0
  v_mul_f32 v136, s61, v124
  v_mul_f32 v137, s61, v125
  v_mul_f32 v138, s61, v126
  v_mul_f32 v139, s61, v127
  v_mul_f32 v140, s61, v128
  v_mul_f32 v141, s61, v129
  v_mul_f32 v142, s61, v130
  v_mul_f32 v143, s61, v131
  v_mul_f32 v144, s61, v132
  v_mul_f32 v145, s61, v133
  v_mul_f32 v146, s61, v134
  v_mul_f32 v147, s61, v135
  v_exp_f32 v136, -v136
  v_exp_f32 v137, -v137
  v_exp_f32 v138, -v138
  v_exp_f32 v139, -v139
  v_exp_f32 v140, -v140
  v_exp_f32 v141, -v141
  v_exp_f32 v142, -v142
  v_exp_f32 v143, -v143
  v_exp_f32 v144, -v144
  v_exp_f32 v145, -v145
  v_exp_f32 v146, -v146
  v_exp_f32 v147, -v147
  s_nop 0
  v_add_f32 v136, 1.0, v136
  v_add_f32 v137, 1.0, v137
  v_add_f32 v138, 1.0, v138
  v_add_f32 v139, 1.0, v139
  v_add_f32 v140, 1.0, v140
  v_add_f32 v141, 1.0, v141
  v_add_f32 v142, 1.0, v142
  v_add_f32 v143, 1.0, v143
  v_add_f32 v144, 1.0, v144
  v_add_f32 v145, 1.0, v145
  v_add_f32 v146, 1.0, v146
  v_add_f32 v147, 1.0, v147
  v_rcp_f32 v136, v136
  v_rcp_f32 v137, v137
  v_rcp_f32 v138, v138
  v_rcp_f32 v139, v139
  v_rcp_f32 v140, v140
  v_rcp_f32 v141, v141
  v_rcp_f32 v142, v142
  v_rcp_f32 v143, v143
  v_rcp_f32 v144, v144
  v_rcp_f32 v145, v145
  v_rcp_f32 v146, v146
  v_rcp_f32 v147, v147
  s_nop 0
  v_mul_f32 v136, v124, v136
  v_mul_f32 v137, v125, v137
  v_mul_f32 v138, v126, v138
  v_mul_f32 v139, v127, v139
  v_mul_f32 v140, v128, v140
  v_mul_f32 v141, v129, v141
  v_mul_f32 v142, v130, v142
  v_mul_f32 v143, v131, v143
  v_mul_f32 v144, v132, v144
  v_mul_f32 v145, v133, v145
  v_mul_f32 v146, v134, v146
  v_mul_f32 v147, v135, v147
  v_cvt_pk_bf16_f32 v136, v136, v136
  v_and_b32 v136, 0xffff0000, v136
  v_cvt_pk_bf16_f32 v137, v137, v137
  v_and_b32 v137, 0xffff0000, v137
  v_cvt_pk_bf16_f32 v138, v138, v138
  v_and_b32 v138, 0xffff0000, v138
  v_cvt_pk_bf16_f32 v139, v139, v139
  v_and_b32 v139, 0xffff0000, v139
  v_cvt_pk_bf16_f32 v140, v140, v140
  v_and_b32 v140, 0xffff0000, v140
  v_cvt_pk_bf16_f32 v141, v141, v141
  v_and_b32 v141, 0xffff0000, v141
  v_cvt_pk_bf16_f32 v142, v142, v142
  v_and_b32 v142, 0xffff0000, v142
  v_cvt_pk_bf16_f32 v143, v143, v143
  v_and_b32 v143, 0xffff0000, v143
  v_cvt_pk_bf16_f32 v144, v144, v144
  v_and_b32 v144, 0xffff0000, v144
  v_cvt_pk_bf16_f32 v145, v145, v145
  v_and_b32 v145, 0xffff0000, v145
  v_cvt_pk_bf16_f32 v146, v146, v146
  v_and_b32 v146, 0xffff0000, v146
  v_cvt_pk_bf16_f32 v147, v147, v147
  v_and_b32 v147, 0xffff0000, v147
  v_mul_f32 v136, v136, v148
  v_mul_f32 v137, v137, v149
  v_mul_f32 v138, v138, v150
  v_mul_f32 v139, v139, v151
  v_mul_f32 v140, v140, v152
  v_mul_f32 v141, v141, v153
  v_mul_f32 v142, v142, v154
  v_mul_f32 v143, v143, v155
  v_mul_f32 v144, v144, v156
  v_mul_f32 v145, v145, v157
  v_mul_f32 v146, v146, v158
  v_mul_f32 v147, v147, v159
  v_cvt_pk_bf16_f32 v136, v136, v136
  v_cvt_pk_bf16_f32 v137, v137, v137
  v_cvt_pk_bf16_f32 v138, v138, v138
  v_cvt_pk_bf16_f32 v139, v139, v139
  v_cvt_pk_bf16_f32 v140, v140, v140
  v_cvt_pk_bf16_f32 v141, v141, v141
  v_cvt_pk_bf16_f32 v142, v142, v142
  v_cvt_pk_bf16_f32 v143, v143, v143
  v_cvt_pk_bf16_f32 v144, v144, v144
  v_cvt_pk_bf16_f32 v145, v145, v145
  v_cvt_pk_bf16_f32 v146, v146, v146
  v_cvt_pk_bf16_f32 v147, v147, v147
  v_lshrrev_b32 v3, 3, v1
  v_mul_u32_u24 v3, 96, v3
  v_and_b32 v4, 7, v1
  v_add_u32 v3, v3, v4
  v_lshlrev_b32 v3, 2, v3
  ds_write_b32 v3, v136 offset:18944
  ds_write_b32 v3, v137 offset:18976
  ds_write_b32 v3, v138 offset:19008
  ds_write_b32 v3, v139 offset:19040
  ds_write_b32 v3, v140 offset:19072
  ds_write_b32 v3, v141 offset:19104
  ds_write_b32 v3, v142 offset:19136
  ds_write_b32 v3, v143 offset:19168
  ds_write_b32 v3, v144 offset:19200
  ds_write_b32 v3, v145 offset:19232
  ds_write_b32 v3, v146 offset:19264
  ds_write_b32 v3, v147 offset:19296
  s_waitcnt lgkmcnt(0)
  v_mov_b32 v4, 0
  v_mov_b32 v5, 1
  ds_write_b32 v4, v5 offset:12
L_noh:
  s_mul_i32 s31, s55, 96
  s_mul_i32 s32, s28, 24
  s_add_u32 s31, s31, s32
  s_mul_i32 s31, s31, 1152
  s_mul_i32 s32, s59, 384
  s_add_u32 s31, s31, s32
  s_mov_b64 s[36:37], s[20:21]
  s_add_u32 s36, s36, s31
  s_addc_u32 s37, s37, 0
  v_mul_u32_u24 v5, 2304, v2
  v_lshl_add_u32 v5, v1, 4, v5
  v_add_u32 v6, 256, v5
  v_add_u32 v7, 1024, v5
  v_cmp_gt_u32_e32 vcc, 8, v1
  s_nop 1
  v_cndmask_b32_e32 v6, v7, v6, vcc
  s_mov_b32 s49, 1048576
  v_mov_b32 v12, 0
L_viss_lp_19:
  ds_read_b32 v13, v12 offset:36
  s_waitcnt lgkmcnt(0)
  v_readfirstlane_b32 s31, v13
  s_cmp_ge_u32 s31, 8
  s_cbranch_scc1 L_viss_ok_20
  s_sub_u32 s49, s49, 1
  s_cbranch_scc1 L_viss_ok_20
  s_sleep 4
  s_branch L_viss_lp_19
L_viss_ok_20:
  global_load_dwordx4 v[88:91], v5, s[36:37] nt
  global_load_dwordx4 v[92:95], v6, s[36:37] nt
  global_load_dwordx4 v[96:99], v5, s[36:37] offset:1280 nt
  s_add_u32 s36, s36, 9216
  s_addc_u32 s37, s37, 0
  global_load_dwordx4 v[100:103], v5, s[36:37] nt
  global_load_dwordx4 v[104:107], v6, s[36:37] nt
  global_load_dwordx4 v[108:111], v5, s[36:37] offset:1280 nt
  s_add_u32 s36, s36, 9216
  s_addc_u32 s37, s37, 0
  global_load_dwordx4 v[112:115], v5, s[36:37] nt
  global_load_dwordx4 v[116:119], v6, s[36:37] nt
  global_load_dwordx4 v[120:123], v5, s[36:37] offset:1280 nt
  s_mul_i32 s31, s28, 3072
  v_lshlrev_b32 v60, 4, v0
  v_add_u32 v60, s31, v60
  s_mul_i32 s31, s28, 24
  v_add_u32 v62, s31, v0
  v_lshlrev_b32 v61, 4, v62
  v_lshrrev_b32 v6, 4, v62
  v_bfe_u32 v7, v62, 3, 1
  v_mad_u32_u24 v6, v7, 18, v6
  v_mul_u32_u24 v6, 6144, v6
  v_and_b32 v7, 7, v62
  v_lshl_add_u32 v62, v7, 4, v6
  s_mul_i32 s31, s59, 36864
  s_lshl_b32 s32, s55, 7
  s_add_u32 s31, s31, s32
  s_add_u32 s31, s31, 1572864
  s_mov_b64 s[80:81], s[26:27]
  s_add_u32 s80, s80, s31
  s_addc_u32 s81, s81, 0
  s_mov_b32 s49, 1048576
  v_mov_b32 v12, 0
L_hf_lp_21:
  ds_read_b32 v13, v12 offset:12
  s_waitcnt lgkmcnt(0)
  v_readfirstlane_b32 s31, v13
  s_cmp_ge_u32 s31, 1
  s_cbranch_scc1 L_hf_ok_22
  s_sub_u32 s49, s49, 1
  s_cbranch_scc1 L_hf_ok_22
  s_sleep 2
  s_branch L_hf_lp_21
L_hf_ok_22:
  v_lshrrev_b32 v3, 3, v1
  v_mul_u32_u24 v3, 96, v3
  v_lshl_add_u32 v3, v2, 1, v3
  s_mul_i32 s31, s28, 24
  v_add_u32 v3, s31, v3
  v_lshlrev_b32 v3, 2, v3
  ds_read_b64 v[16:17], v3 offset:18944
  ds_read_b64 v[18:19], v3 offset:18976
  ds_read_b64 v[20:21], v3 offset:19008
  s_waitcnt lgkmcnt(2)
  v_and_b32 v40, v16, v8
  v_and_b32 v41, v16, v9
  v_and_b32 v42, v16, v10
  v_and_b32 v43, v16, v11
  v_and_b32 v44, v17, v8
  v_and_b32 v45, v17, v9
  v_and_b32 v46, v17, v10
  v_and_b32 v47, v17, v11
  s_waitcnt lgkmcnt(1)
  s_waitcnt vmcnt(6)
  s_nop 0
  v_mfma_f32_16x16x32_bf16 v[24:27], v[88:91], v[40:43], 0
  v_and_b32 v48, v18, v8
  v_and_b32 v49, v18, v9
  v_mfma_f32_16x16x32_bf16 v[28:31], v[92:95], v[40:43], 0
  v_and_b32 v50, v18, v10
  v_and_b32 v51, v18, v11
  v_mfma_f32_16x16x32_bf16 v[32:35], v[92:95], v[44:47], 0
  v_and_b32 v52, v19, v8
  v_and_b32 v53, v19, v9
  v_mfma_f32_16x16x32_bf16 v[36:39], v[96:99], v[44:47], 0
  v_and_b32 v54, v19, v10
  v_and_b32 v55, v19, v11
  s_waitcnt lgkmcnt(0)
  s_waitcnt vmcnt(3)
  v_mfma_f32_16x16x32_bf16 v[24:27], v[100:103], v[48:51], v[24:27]
  v_and_b32 v40, v20, v8
  v_and_b32 v41, v20, v9
  v_mfma_f32_16x16x32_bf16 v[28:31], v[104:107], v[48:51], v[28:31]
  v_and_b32 v42, v20, v10
  v_and_b32 v43, v20, v11
  v_mfma_f32_16x16x32_bf16 v[32:35], v[104:107], v[52:55], v[32:35]
  v_and_b32 v44, v21, v8
  v_and_b32 v45, v21, v9
  v_mfma_f32_16x16x32_bf16 v[36:39], v[108:111], v[52:55], v[36:39]
  v_and_b32 v46, v21, v10
  v_and_b32 v47, v21, v11
  s_waitcnt vmcnt(0)
  v_mfma_f32_16x16x32_bf16 v[24:27], v[112:115], v[40:43], v[24:27]
  v_mfma_f32_16x16x32_bf16 v[28:31], v[116:119], v[40:43], v[28:31]
  v_mfma_f32_16x16x32_bf16 v[32:35], v[116:119], v[44:47], v[32:35]
  v_mfma_f32_16x16x32_bf16 v[36:39], v[120:123], v[44:47], v[36:39]
  v_cmp_gt_u32_e32 vcc, 2, v2
  v_mov_b32 v12, 0
  v_mov_b32 v13, 1
  s_nop 4
  ds_write_b128 v60, v[24:27] offset:21504
  v_cndmask_b32_e32 v28, v32, v28, vcc
  v_cndmask_b32_e32 v29, v33, v29, vcc
  v_cndmask_b32_e32 v30, v34, v30, vcc
  v_cndmask_b32_e32 v31, v35, v31, vcc
  ds_write_b128 v60, v[36:39] offset:23552
  ds_write_b128 v60, v[28:31] offset:22528
  s_mov_b64 s[52:53], exec
  s_waitcnt lgkmcnt(0)
  s_barrier
  s_mov_b64 exec, 0xffffff
  ds_read_b128 v[64:67], v61 offset:21504
  ds_read_b128 v[68:71], v61 offset:23040
  ds_read_b128 v[72:75], v61 offset:24576
  ds_read_b128 v[76:79], v61 offset:26112
  ds_read_b128 v[80:83], v61 offset:27648
  ds_read_b128 v[84:87], v61 offset:29184
  ds_read_b128 v[88:91], v61 offset:30720
  ds_read_b128 v[92:95], v61 offset:32256
  s_waitcnt lgkmcnt(6)
  v_add_f32 v64, v64, v68
  v_add_f32 v65, v65, v69
  v_add_f32 v66, v66, v70
  v_add_f32 v67, v67, v71
  s_waitcnt lgkmcnt(4)
  v_add_f32 v72, v72, v76
  v_add_f32 v64, v64, v72
  v_add_f32 v73, v73, v77
  v_add_f32 v65, v65, v73
  v_add_f32 v74, v74, v78
  v_add_f32 v66, v66, v74
  v_add_f32 v75, v75, v79
  v_add_f32 v67, v67, v75
  s_waitcnt lgkmcnt(2)
  v_add_f32 v80, v80, v84
  v_add_f32 v64, v64, v80
  v_add_f32 v81, v81, v85
  v_add_f32 v65, v65, v81
  v_add_f32 v82, v82, v86
  v_add_f32 v66, v66, v82
  v_add_f32 v83, v83, v87
  v_add_f32 v67, v67, v83
  s_waitcnt lgkmcnt(0)
  v_add_f32 v88, v88, v92
  v_add_f32 v64, v64, v88
  v_add_f32 v89, v89, v93
  v_add_f32 v65, v65, v89
  v_add_f32 v90, v90, v94
  v_add_f32 v66, v66, v90
  v_add_f32 v91, v91, v95
  v_add_f32 v67, v67, v91
  v_perm_b32 v68, v64, v14, s41
  v_perm_b32 v69, v65, v14, s42
  v_perm_b32 v70, v66, v14, s43
  v_perm_b32 v71, v67, v14, s44
  global_store_dwordx4 v62, v[68:71], s[80:81] sc1
  s_mov_b64 exec, s[52:53]
  s_branch L_end_stamp
L_roleQtail:
  s_and_b32 s31, s28, 1
  s_cmp_lg_u32 s28, 0
  s_cbranch_scc1 L_end_stamp
  s_sub_u32 s60, s30, 18
  s_lshl_b32 s60, s60, 3
  s_add_u32 s60, s60, s29
  s_cmp_ge_u32 s60, 36
  s_cbranch_scc1 L_end_stamp
  v_and_b32 v3, 7, v0
  v_lshlrev_b32 v3, 1, v3
  s_lshl_b32 s31, s60, 6
  v_add_u32 v3, s31, v3
  global_load_ushort v124, v3, s[4:5] offset:0
  global_load_ushort v125, v3, s[4:5] offset:16
  global_load_ushort v126, v3, s[4:5] offset:32
  global_load_ushort v127, v3, s[4:5] offset:48
  v_lshlrev_b32 v4, 4, v0
  v_add_u32 v5, 4096, v4
  s_mul_i32 s31, s60, 6144
  s_add_u32 s31, s31, 1572864
  s_mov_b64 s[36:37], s[26:27]
  s_add_u32 s36, s36, s31
  s_addc_u32 s37, s37, 0
  s_lshl_b32 s31, s60, 11
  s_add_u32 s31, s31, 2359296
  s_mov_b64 s[38:39], s[26:27]
  s_add_u32 s38, s38, s31
  s_addc_u32 s39, s39, 0
  s_mov_b32 s49, 1048576
  v_mov_b32 v12, 0
L_own_lp_23:
  ds_read_b32 v13, v12 offset:16
  s_waitcnt lgkmcnt(0)
  v_readfirstlane_b32 s31, v13
  s_cmp_ge_u32 s31, 8
  s_cbranch_scc1 L_own_ok_24
  s_sub_u32 s49, s49, 1
  s_cbranch_scc1 L_own_ok_24
  s_sleep 8
  s_branch L_own_lp_23
L_own_ok_24:
  s_mov_b32 s49, 131072
  s_mov_b32 s63, 63
L_fin_lp_25:
  s_bitcmp1_b32 s63, 0
  s_cbranch_scc0 L_sk_27
  global_load_dwordx4 v[16:19], v4, s[36:37] offset:0 sc1
L_sk_27:
  s_bitcmp1_b32 s63, 1
  s_cbranch_scc0 L_sk_28
  global_load_dwordx4 v[20:23], v4, s[36:37] offset:1024 sc1
L_sk_28:
  s_bitcmp1_b32 s63, 2
  s_cbranch_scc0 L_sk_29
  global_load_dwordx4 v[24:27], v4, s[36:37] offset:2048 sc1
L_sk_29:
  s_bitcmp1_b32 s63, 3
  s_cbranch_scc0 L_sk_30
  global_load_dwordx4 v[28:31], v4, s[36:37] offset:3072 sc1
L_sk_30:
  s_bitcmp1_b32 s63, 4
  s_cbranch_scc0 L_sk_31
  global_load_dwordx4 v[32:35], v5, s[36:37] offset:0 sc1
L_sk_31:
  s_bitcmp1_b32 s63, 5
  s_cbranch_scc0 L_sk_32
  global_load_dwordx4 v[36:39], v5, s[36:37] offset:1024 sc1
L_sk_32:
  s_waitcnt vmcnt(0)
  s_bitcmp1_b32 s63, 0
  s_cbranch_scc0 L_sk_33
  v_perm_b32 v13, v17, v16, s45
  v_perm_b32 v15, v19, v18, s46
  v_or_b32 v13, v13, v15
  v_cmp_eq_u32_e64 s[50:51], s40, v13
  s_cmp_eq_u64 s[50:51], -1
  s_cbranch_scc0 L_sk_33
  s_bitset0_b32 s63, 0
L_sk_33:
  s_bitcmp1_b32 s63, 1
  s_cbranch_scc0 L_sk_34
  v_perm_b32 v13, v21, v20, s45
  v_perm_b32 v15, v23, v22, s46
  v_or_b32 v13, v13, v15
  v_cmp_eq_u32_e64 s[50:51], s40, v13
  s_cmp_eq_u64 s[50:51], -1
  s_cbranch_scc0 L_sk_34
  s_bitset0_b32 s63, 1
L_sk_34:
  s_bitcmp1_b32 s63, 2
  s_cbranch_scc0 L_sk_35
  v_perm_b32 v13, v25, v24, s45
  v_perm_b32 v15, v27, v26, s46
  v_or_b32 v13, v13, v15
  v_cmp_eq_u32_e64 s[50:51], s40, v13
  s_cmp_eq_u64 s[50:51], -1
  s_cbranch_scc0 L_sk_35
  s_bitset0_b32 s63, 2
L_sk_35:
  s_bitcmp1_b32 s63, 3
  s_cbranch_scc0 L_sk_36
  v_perm_b32 v13, v29, v28, s45
  v_perm_b32 v15, v31, v30, s46
  v_or_b32 v13, v13, v15
  v_cmp_eq_u32_e64 s[50:51], s40, v13
  s_cmp_eq_u64 s[50:51], -1
  s_cbranch_scc0 L_sk_36
  s_bitset0_b32 s63, 3
L_sk_36:
  s_bitcmp1_b32 s63, 4
  s_cbranch_scc0 L_sk_37
  v_perm_b32 v13, v33, v32, s45
  v_perm_b32 v15, v35, v34, s46
  v_or_b32 v13, v13, v15
  v_cmp_eq_u32_e64 s[50:51], s40, v13
  s_cmp_eq_u64 s[50:51], -1
  s_cbranch_scc0 L_sk_37
  s_bitset0_b32 s63, 4
L_sk_37:
  s_bitcmp1_b32 s63, 5
  s_cbranch_scc0 L_sk_38
  v_perm_b32 v13, v37, v36, s45
  v_perm_b32 v15, v39, v38, s46
  v_or_b32 v13, v13, v15
  v_cmp_eq_u32_e64 s[50:51], s40, v13
  s_cmp_eq_u64 s[50:51], -1
  s_cbranch_scc0 L_sk_38
  s_bitset0_b32 s63, 5
L_sk_38:
  s_cmp_eq_u32 s63, 0
  s_cbranch_scc1 L_fin_ok_26
  s_sub_u32 s49, s49, 1
  s_cbranch_scc1 L_fin_ok_26
  s_sleep 2
  s_branch L_fin_lp_25
L_fin_ok_26:
  v_and_b32 v16, 0xffffff00, v16
  v_and_b32 v17, 0xffffff00, v17
  v_and_b32 v18, 0xffffff00, v18
  v_and_b32 v19, 0xffffff00, v19
  v_and_b32 v20, 0xffffff00, v20
  v_and_b32 v21, 0xffffff00, v21
  v_and_b32 v22, 0xffffff00, v22
  v_and_b32 v23, 0xffffff00, v23
  v_and_b32 v24, 0xffffff00, v24
  v_and_b32 v25, 0xffffff00, v25
  v_and_b32 v26, 0xffffff00, v26
  v_and_b32 v27, 0xffffff00, v27
  v_and_b32 v28, 0xffffff00, v28
  v_and_b32 v29, 0xffffff00, v29
  v_and_b32 v30, 0xffffff00, v30
  v_and_b32 v31, 0xffffff00, v31
  v_and_b32 v32, 0xffffff00, v32
  v_and_b32 v33, 0xffffff00, v33
  v_and_b32 v34, 0xffffff00, v34
  v_and_b32 v35, 0xffffff00, v35
  v_and_b32 v36, 0xffffff00, v36
  v_and_b32 v37, 0xffffff00, v37
  v_and_b32 v38, 0xffffff00, v38
  v_and_b32 v39, 0xffffff00, v39
  v_add_f32 v16, v16, v20
  v_add_f32 v17, v17, v21
  v_add_f32 v18, v18, v22
  v_add_f32 v19, v19, v23
  v_add_f32 v16, v16, v24
  v_add_f32 v17, v17, v25
  v_add_f32 v18, v18, v26
  v_add_f32 v19, v19, v27
  v_add_f32 v16, v16, v28
  v_add_f32 v17, v17, v29
  v_add_f32 v18, v18, v30
  v_add_f32 v19, v19, v31
  v_add_f32 v16, v16, v32
  v_add_f32 v17, v17, v33
  v_add_f32 v18, v18, v34
  v_add_f32 v19, v19, v35
  v_add_f32 v16, v16, v36
  v_add_f32 v17, v17, v37
  v_add_f32 v18, v18, v38
  v_add_f32 v19, v19, v39
  s_nop 1
  v_add_f32_dpp v16, v16, v16 row_ror:8 row_mask:0xf bank_mask:0xf
  v_add_f32_dpp v17, v17, v17 row_ror:8 row_mask:0xf bank_mask:0xf
  v_add_f32_dpp v18, v18, v18 row_ror:8 row_mask:0xf bank_mask:0xf
  v_add_f32_dpp v19, v19, v19 row_ror:8 row_mask:0xf bank_mask:0xf
  v_mov_b32 v96, v16
  v_mov_b32 v97, v17
  v_mov_b32 v98, v18
  v_mov_b32 v99, v19
  s_nop 1
  v_permlane16_swap_b32 v16, v96
  v_permlane16_swap_b32 v17, v97
  v_permlane16_swap_b32 v18, v98
  v_permlane16_swap_b32 v19, v99
  s_nop 0
  v_add_f32 v16, v16, v96
  v_add_f32 v17, v17, v97
  v_add_f32 v18, v18, v98
  v_add_f32 v19, v19, v99
  v_mov_b32 v96, v16
  v_mov_b32 v97, v17
  v_mov_b32 v98, v18
  v_mov_b32 v99, v19
  s_nop 1
  v_permlane32_swap_b32 v16, v96
  v_permlane32_swap_b32 v17, v97
  v_permlane32_swap_b32 v18, v98
  v_permlane32_swap_b32 v19, v99
  s_nop 0
  v_add_f32 v16, v16, v96
  v_add_f32 v17, v17, v97
  v_add_f32 v18, v18, v98
  v_add_f32 v19, v19, v99
  v_cvt_pk_bf16_f32 v16, v16, v16
  v_and_b32 v16, 0xffff0000, v16
  v_cvt_pk_bf16_f32 v17, v17, v17
  v_and_b32 v17, 0xffff0000, v17
  v_cvt_pk_bf16_f32 v18, v18, v18
  v_and_b32 v18, 0xffff0000, v18
  v_cvt_pk_bf16_f32 v19, v19, v19
  v_and_b32 v19, 0xffff0000, v19
  v_lshlrev_b32 v124, 16, v124
  v_lshlrev_b32 v125, 16, v125
  v_lshlrev_b32 v126, 16, v126
  v_lshlrev_b32 v127, 16, v127
  s_mov_b32 s49, 131072
  global_load_dwordx4 v[64:67], v4, s[38:39] offset:0 sc1
  global_load_dwordx4 v[68:71], v4, s[38:39] offset:1024 sc1
  global_load_dwordx4 v[72:75], v4, s[38:39] offset:0 sc1
  global_load_dwordx4 v[76:79], v4, s[38:39] offset:1024 sc1
L_fp_lp_39:
  global_load_dwordx4 v[80:83], v4, s[38:39] offset:0 sc1
  global_load_dwordx4 v[84:87], v4, s[38:39] offset:1024 sc1
  s_waitcnt vmcnt(4)
  v_perm_b32 v13, v65, v64, s45
  v_perm_b32 v15, v67, v66, s46
  v_or_b32 v13, v13, v15
  v_cmp_eq_u32_e64 s[50:51], s40, v13
  v_perm_b32 v13, v69, v68, s45
  v_perm_b32 v15, v71, v70, s46
  v_or_b32 v13, v13, v15
  v_cmp_eq_u32_e32 vcc, s40, v13
  s_and_b64 s[50:51], s[50:51], vcc
  s_cmp_eq_u64 s[50:51], -1
  s_cbranch_scc1 L_fp_ok_41
  global_load_dwordx4 v[64:67], v4, s[38:39] offset:0 sc1
  global_load_dwordx4 v[68:71], v4, s[38:39] offset:1024 sc1
  s_waitcnt vmcnt(4)
  v_perm_b32 v13, v73, v72, s45
  v_perm_b32 v15, v75, v74, s46
  v_or_b32 v13, v13, v15
  v_cmp_eq_u32_e64 s[50:51], s40, v13
  v_perm_b32 v13, v77, v76, s45
  v_perm_b32 v15, v79, v78, s46
  v_or_b32 v13, v13, v15
  v_cmp_eq_u32_e32 vcc, s40, v13
  s_and_b64 s[50:51], s[50:51], vcc
  s_cmp_eq_u64 s[50:51], -1
  s_cbranch_scc1 L_fp_ok_42
  global_load_dwordx4 v[72:75], v4, s[38:39] offset:0 sc1
  global_load_dwordx4 v[76:79], v4, s[38:39] offset:1024 sc1
  s_waitcnt vmcnt(4)
  v_perm_b32 v13, v81, v80, s45
  v_perm_b32 v15, v83, v82, s46
  v_or_b32 v13, v13, v15
  v_cmp_eq_u32_e64 s[50:51], s40, v13
  v_perm_b32 v13, v85, v84, s45
  v_perm_b32 v15, v87, v86, s46
  v_or_b32 v13, v13, v15
  v_cmp_eq_u32_e32 vcc, s40, v13
  s_and_b64 s[50:51], s[50:51], vcc
  s_cmp_eq_u64 s[50:51], -1
  s_cbranch_scc1 L_fp_ok_43
  s_sub_u32 s49, s49, 1
  s_cbranch_scc0 L_fp_lp_39
L_fp_ok_41:
  v_and_b32 v64, 0xffffff00, v64
  v_and_b32 v65, 0xffffff00, v65
  v_and_b32 v66, 0xffffff00, v66
  v_and_b32 v67, 0xffffff00, v67
  v_and_b32 v68, 0xffffff00, v68
  v_and_b32 v69, 0xffffff00, v69
  v_and_b32 v70, 0xffffff00, v70
  v_and_b32 v71, 0xffffff00, v71
  v_add_f32 v40, v64, v68
  v_add_f32 v41, v65, v69
  v_add_f32 v42, v66, v70
  v_add_f32 v43, v67, v71
  s_branch L_fp_done_40
L_fp_ok_42:
  v_and_b32 v72, 0xffffff00, v72
  v_and_b32 v73, 0xffffff00, v73
  v_and_b32 v74, 0xffffff00, v74
  v_and_b32 v75, 0xffffff00, v75
  v_and_b32 v76, 0xffffff00, v76
  v_and_b32 v77, 0xffffff00, v77
  v_and_b32 v78, 0xffffff00, v78
  v_and_b32 v79, 0xffffff00, v79
  v_add_f32 v40, v72, v76
  v_add_f32 v41, v73, v77
  v_add_f32 v42, v74, v78
  v_add_f32 v43, v75, v79
  s_branch L_fp_done_40
L_fp_ok_43:
  v_and_b32 v80, 0xffffff00, v80
  v_and_b32 v81, 0xffffff00, v81
  v_and_b32 v82, 0xffffff00, v82
  v_and_b32 v83, 0xffffff00, v83
  v_and_b32 v84, 0xffffff00, v84
  v_and_b32 v85, 0xffffff00, v85
  v_and_b32 v86, 0xffffff00, v86
  v_and_b32 v87, 0xffffff00, v87
  v_add_f32 v40, v80, v84
  v_add_f32 v41, v81, v85
  v_add_f32 v42, v82, v86
  v_add_f32 v43, v83, v87
L_fp_done_40:
  s_nop 1
  v_add_f32_dpp v40, v40, v40 row_ror:8 row_mask:0xf bank_mask:0xf
  v_add_f32_dpp v41, v41, v41 row_ror:8 row_mask:0xf bank_mask:0xf
  v_add_f32_dpp v42, v42, v42 row_ror:8 row_mask:0xf bank_mask:0xf
  v_add_f32_dpp v43, v43, v43 row_ror:8 row_mask:0xf bank_mask:0xf
  v_mov_b32 v96, v40
  v_mov_b32 v97, v41
  v_mov_b32 v98, v42
  v_mov_b32 v99, v43
  s_nop 1
  v_permlane16_swap_b32 v40, v96
  v_permlane16_swap_b32 v41, v97
  v_permlane16_swap_b32 v42, v98
  v_permlane16_swap_b32 v43, v99
  s_nop 0
  v_add_f32 v40, v40, v96
  v_add_f32 v41, v41, v97
  v_add_f32 v42, v42, v98
  v_add_f32 v43, v43, v99
  v_mov_b32 v96, v40
  v_mov_b32 v97, v41
  v_mov_b32 v98, v42
  v_mov_b32 v99, v43
  s_nop 1
  v_permlane32_swap_b32 v40, v96
  v_permlane32_swap_b32 v41, v97
  v_permlane32_swap_b32 v42, v98
  v_permlane32_swap_b32 v43, v99
  s_nop 0
  v_add_f32 v40, v40, v96
  v_add_f32 v41, v41, v97
  v_add_f32 v42, v42, v98
  v_add_f32 v43, v43, v99
  v_cvt_pk_bf16_f32 v40, v40, v40
  v_and_b32 v40, 0xffff0000, v40
  v_cvt_pk_bf16_f32 v41, v41, v41
  v_and_b32 v41, 0xffff0000, v41
  v_cvt_pk_bf16_f32 v42, v42, v42
  v_and_b32 v42, 0xffff0000, v42
  v_cvt_pk_bf16_f32 v43, v43, v43
  v_and_b32 v43, 0xffff0000, v43
  v_add_f32 v40, v124, v40
  v_add_f32 v41, v125, v41
  v_add_f32 v42, v126, v42
  v_add_f32 v43, v127, v43
  v_cvt_pk_bf16_f32 v40, v40, v40
  v_and_b32 v40, 0xffff0000, v40
  v_cvt_pk_bf16_f32 v41, v41, v41
  v_and_b32 v41, 0xffff0000, v41
  v_cvt_pk_bf16_f32 v42, v42, v42
  v_and_b32 v42, 0xffff0000, v42
  v_cvt_pk_bf16_f32 v43, v43, v43
  v_and_b32 v43, 0xffff0000, v43
  v_add_f32 v40, v40, v16
  v_add_f32 v41, v41, v17
  v_add_f32 v42, v42, v18
  v_add_f32 v43, v43, v19
  v_cvt_pk_bf16_f32 v28, v40, v41
  v_cvt_pk_bf16_f32 v29, v42, v43
  v_cmp_gt_u32_e32 vcc, 8, v0
  s_and_saveexec_b64 s[52:53], vcc
  global_store_short v3, v28, s[22:23]
  global_store_short_d16_hi v3, v28, s[22:23] offset:16
  global_store_short v3, v29, s[22:23] offset:32
  global_store_short_d16_hi v3, v29, s[22:23] offset:48
  s_cmp_lg_u32 s60, 0
  s_cbranch_scc1 L_nobump
  s_mov_b64 exec, 1
  v_mov_b32 v4, 0
  ds_read_b32 v5, v4 offset:28
  s_waitcnt lgkmcnt(0)
  global_store_dword v4, v5, s[26:27] sc1
L_nobump:
  s_mov_b64 exec, s[52:53]
  s_branch L_end_stamp
L_roleO:
  s_sub_u32 s59, s30, 26
  s_cmp_ge_u32 s59, 3
  s_cselect_b32 s31, 1, 0
  s_mul_i32 s32, s31, 3
  s_sub_u32 s59, s59, s32
  s_lshl_b32 s47, s29, 1
  s_add_u32 s47, s47, s31
  s_waitcnt lgkmcnt(0)
  s_cmp_lg_u32 s28, 1
  s_cbranch_scc1 L_nogenO
  s_load_dword s40, s[26:27], 0
L_nogenO:
  s_mul_i32 s31, s47, 294912
  s_mul_i32 s32, s59, 384
  s_add_u32 s31, s31, s32
  s_mul_i32 s32, s28, 73728
  s_add_u32 s31, s31, s32
  s_mov_b64 s[82:83], s[12:13]
  s_add_u32 s82, s82, s31
  s_addc_u32 s83, s83, 0
  v_mul_u32_u24 v5, 2304, v2
  v_lshl_add_u32 v5, v1, 4, v5
  v_add_u32 v6, 256, v5
  v_add_u32 v7, 1024, v5
  v_cmp_gt_u32_e32 vcc, 8, v1
  s_nop 1
  v_cndmask_b32_e32 v6, v7, v6, vcc
  v_mov_b32 v165, v5
  v_mov_b32 v166, v6
  s_barrier
  s_cmp_lg_u32 s28, 1
  s_cbranch_scc1 L_Onoq
  s_waitcnt lgkmcnt(0)
  s_add_u32 s40, s40, 1
  s_and_b32 s31, s40, 0xff
  s_mul_i32 s31, s31, 0x01010100
  s_mov_b32 s32, s40
  s_xor_b32 s40, s40, s31
  v_mov_b32 v4, 0
  v_mov_b32 v5, s40
  v_mov_b32 v6, s32
  ds_write_b32 v4, v5 offset:4
  ds_write_b32 v4, v6 offset:28
  s_waitcnt lgkmcnt(0)
  v_mov_b32 v5, 1
  ds_write_b32 v4, v5 offset:0
  s_lshl_b32 s31, s56, 12
  s_lshl_b32 s32, s57, 7
  s_add_u32 s31, s31, s32
  s_add_u32 s31, s31, 151552
  s_mov_b64 s[38:39], s[26:27]
  s_add_u32 s38, s38, s31
  s_addc_u32 s39, s39, 0
  v_lshrrev_b32 v3, 5, v0
  v_lshlrev_b32 v3, 11, v3
  v_bfe_u32 v4, v0, 3, 2
  v_lshl_add_u32 v3, v4, 8, v3
  v_and_b32 v4, 7, v0
  v_lshl_add_u32 v3, v4, 4, v3
  s_and_b32 s62, s40, 0xff
  s_mov_b32 s49, 131072
L_qp_lp_44:
  s_load_dword s84, s[38:39], 0 glc
  s_load_dword s85, s[38:39], 1024 glc
  s_load_dword s86, s[38:39], 2048 glc
  s_load_dword s87, s[38:39], 3072 glc
  s_waitcnt lgkmcnt(0)
  s_and_b32 s84, s84, 0xff
  s_xor_b32 s84, s84, s62
  s_and_b32 s85, s85, 0xff
  s_xor_b32 s85, s85, s62
  s_and_b32 s86, s86, 0xff
  s_xor_b32 s86, s86, s62
  s_and_b32 s87, s87, 0xff
  s_xor_b32 s87, s87, s62
  s_or_b32 s84, s84, s85
  s_or_b32 s86, s86, s87
  s_or_b32 s84, s84, s86
  s_cmp_eq_u32 s84, 0
  s_cbranch_scc1 L_qp_ok_45
  s_sub_u32 s49, s49, 1
  s_cbranch_scc1 L_qp_ok_45
  s_sleep 8
  s_branch L_qp_lp_44
L_qp_ok_45:
  v_add_u32 v156, 3796992, v3
  v_mov_b32 v157, v3
  s_mov_b32 s49, 131072
  s_mov_b32 s63, 3
L_q_lp_46:
  s_and_b32 s31, s49, 1
  s_cmp_eq_u32 s31, 1
  s_cselect_b64 vcc, -1, 0
  v_cndmask_b32_e32 v3, v156, v157, vcc
  s_bitcmp1_b32 s63, 0
  s_cbranch_scc0 L_sk_48
  global_load_dwordx4 v[124:127], v3, s[38:39] offset:0 sc1
L_sk_48:
  s_bitcmp1_b32 s63, 1
  s_cbranch_scc0 L_sk_49
  global_load_dwordx4 v[128:131], v3, s[38:39] offset:1024 sc1
L_sk_49:
  s_waitcnt vmcnt(0)
  s_bitcmp1_b32 s63, 0
  s_cbranch_scc0 L_sk_50
  v_perm_b32 v5, v125, v124, s45
  v_perm_b32 v6, v127, v126, s46
  v_or_b32 v5, v5, v6
  v_cmp_eq_u32_e64 s[50:51], s40, v5
  s_cmp_eq_u64 s[50:51], -1
  s_cbranch_scc0 L_sk_50
  s_bitset0_b32 s63, 0
L_sk_50:
  s_bitcmp1_b32 s63, 1
  s_cbranch_scc0 L_sk_51
  v_perm_b32 v5, v129, v128, s45
  v_perm_b32 v6, v131, v130, s46
  v_or_b32 v5, v5, v6
  v_cmp_eq_u32_e64 s[50:51], s40, v5
  s_cmp_eq_u64 s[50:51], -1
  s_cbranch_scc0 L_sk_51
  s_bitset0_b32 s63, 1
L_sk_51:
  s_cmp_eq_u32 s63, 0
  s_cbranch_scc1 L_q_ok_47
  s_sub_u32 s49, s49, 1
  s_cbranch_scc1 L_q_ok_47
  s_sleep 4
  s_branch L_q_lp_46
L_q_ok_47:
  v_and_b32 v124, 0xffffff00, v124
  v_and_b32 v125, 0xffffff00, v125
  v_and_b32 v126, 0xffffff00, v126
  v_and_b32 v127, 0xffffff00, v127
  v_and_b32 v128, 0xffffff00, v128
  v_and_b32 v129, 0xffffff00, v129
  v_and_b32 v130, 0xffffff00, v130
  v_and_b32 v131, 0xffffff00, v131
  v_add_f32 v124, v124, v128
  v_add_f32 v125, v125, v129
  v_add_f32 v126, v126, v130
  v_add_f32 v127, v127, v131
  v_cvt_pk_bf16_f32 v124, v124, v125
  v_cvt_pk_bf16_f32 v126, v126, v127
  v_lshrrev_b32 v3, 5, v0
  v_lshlrev_b32 v3, 8, v3
  v_bfe_u32 v4, v0, 3, 2
  v_lshl_add_u32 v3, v4, 6, v3
  v_and_b32 v4, 7, v0
  v_lshl_add_u32 v3, v4, 1, v3
  ds_write_b16 v3, v124 offset:9728
  ds_write_b16_d16_hi v3, v124 offset:9744
  ds_write_b16 v3, v126 offset:9760
  ds_write_b16_d16_hi v3, v126 offset:9776
  s_waitcnt lgkmcnt(0)
  v_mov_b32 v4, 0
  v_mov_b32 v5, 1
  ds_write_b32 v4, v5 offset:8
L_Onoq:
  s_mov_b32 s49, 1048576
  v_mov_b32 v12, 0
L_tag_lp_52:
  ds_read_b32 v13, v12 offset:0
  s_waitcnt lgkmcnt(0)
  v_readfirstlane_b32 s31, v13
  s_cmp_ge_u32 s31, 1
  s_cbranch_scc1 L_tag_ok_53
  s_sub_u32 s49, s49, 1
  s_cbranch_scc1 L_tag_ok_53
  s_sleep 2
  s_branch L_tag_lp_52
L_tag_ok_53:
  ds_read_b32 v14, v12 offset:4
  s_waitcnt lgkmcnt(0)
  v_readfirstlane_b32 s40, v14
  v_and_b32 v112, 7, v1
  v_and_b32 v113, 1, v112
  v_lshrrev_b32 v112, 1, v112
  v_mov_b32 v114, 0xffff
  v_lshlrev_b32 v113, 4, v113
  v_lshlrev_b32 v113, v113, v114
  v_cmp_eq_u32_e32 vcc, 0, v112
  s_nop 1
  v_cndmask_b32_e32 v8, 0, v113, vcc
  v_cmp_eq_u32_e32 vcc, 1, v112
  s_nop 1
  v_cndmask_b32_e32 v9, 0, v113, vcc
  v_cmp_eq_u32_e32 vcc, 2, v112
  s_nop 1
  v_cndmask_b32_e32 v10, 0, v113, vcc
  v_cmp_eq_u32_e32 vcc, 3, v112
  s_nop 1
  v_cndmask_b32_e32 v11, 0, v113, vcc
  s_mov_b32 s49, 1048576
  v_mov_b32 v12, 0
L_viss_lp_54:
  ds_read_b32 v13, v12 offset:36
  s_waitcnt lgkmcnt(0)
  v_readfirstlane_b32 s31, v13
  s_cmp_ge_u32 s31, 4
  s_cbranch_scc1 L_viss_ok_55
  s_sub_u32 s49, s49, 1
  s_cbranch_scc1 L_viss_ok_55
  s_sleep 4
  s_branch L_viss_lp_54
L_viss_ok_55:
  global_load_dwordx4 v[16:19], v165, s[82:83] nt
  global_load_dwordx4 v[20:23], v166, s[82:83] nt
  global_load_dwordx4 v[24:27], v165, s[82:83] offset:1280 nt
  s_add_u32 s82, s82, 9216
  s_addc_u32 s83, s83, 0
  global_load_dwordx4 v[28:31], v165, s[82:83] nt
  global_load_dwordx4 v[32:35], v166, s[82:83] nt
  global_load_dwordx4 v[36:39], v165, s[82:83] offset:1280 nt
  s_add_u32 s82, s82, 9216
  s_addc_u32 s83, s83, 0
  global_load_dwordx4 v[40:43], v165, s[82:83] nt
  global_load_dwordx4 v[44:47], v166, s[82:83] nt
  global_load_dwordx4 v[48:51], v165, s[82:83] offset:1280 nt
  s_add_u32 s82, s82, 9216
  s_addc_u32 s83, s83, 0
  global_load_dwordx4 v[52:55], v165, s[82:83] nt
  global_load_dwordx4 v[56:59], v166, s[82:83] nt
  global_load_dwordx4 v[60:63], v165, s[82:83] offset:1280 nt
  s_add_u32 s82, s82, 9216
  s_addc_u32 s83, s83, 0
  global_load_dwordx4 v[64:67], v165, s[82:83] nt
  global_load_dwordx4 v[68:71], v166, s[82:83] nt
  global_load_dwordx4 v[72:75], v165, s[82:83] offset:1280 nt
  s_add_u32 s82, s82, 9216
  s_addc_u32 s83, s83, 0
  s_mov_b32 s49, 1048576
  v_mov_b32 v12, 0
L_viss8_lp_56:
  ds_read_b32 v13, v12 offset:36
  s_waitcnt lgkmcnt(0)
  v_readfirstlane_b32 s31, v13
  s_cmp_ge_u32 s31, 8
  s_cbranch_scc1 L_viss8_ok_57
  s_sub_u32 s49, s49, 1
  s_cbranch_scc1 L_viss8_ok_57
  s_sleep 4
  s_branch L_viss8_lp_56
L_viss8_ok_57:
  global_load_dwordx4 v[76:79], v165, s[82:83] nt
  global_load_dwordx4 v[80:83], v166, s[82:83] nt
  global_load_dwordx4 v[84:87], v165, s[82:83] offset:1280 nt
  s_add_u32 s82, s82, 9216
  s_addc_u32 s83, s83, 0
  global_load_dwordx4 v[88:91], v165, s[82:83] nt
  global_load_dwordx4 v[92:95], v166, s[82:83] nt
  global_load_dwordx4 v[96:99], v165, s[82:83] offset:1280 nt
  s_add_u32 s82, s82, 9216
  s_addc_u32 s83, s83, 0
  global_load_dwordx4 v[100:103], v165, s[82:83] nt
  global_load_dwordx4 v[104:107], v166, s[82:83] nt
  global_load_dwordx4 v[108:111], v165, s[82:83] offset:1280 nt
  s_lshl_b32 s31, s47, 14
  s_and_b32 s32, s28, 1
  s_lshl_b32 s32, s32, 9
  s_add_u32 s31, s31, s32
  s_lshr_b32 s32, s28, 1
  s_lshl_b32 s32, s32, 7
  s_add_u32 s31, s31, s32
  s_add_u32 s31, s31, 1048576
  s_mov_b64 s[36:37], s[26:27]
  s_add_u32 s36, s36, s31
  s_addc_u32 s37, s37, 0
  s_lshl_b32 s31, s47, 11
  s_lshr_b32 s32, s28, 1
  s_lshl_b32 s32, s32, 4
  s_add_u32 s31, s31, s32
  s_add_u32 s31, s31, 1310720
  s_mov_b64 s[38:39], s[26:27]
  s_add_u32 s38, s38, s31
  s_addc_u32 s39, s39, 0
  v_lshrrev_b32 v3, 5, v0
  v_bfe_u32 v5, v0, 3, 1
  v_lshl_add_u32 v4, v3, 1, v5
  v_lshlrev_b32 v3, 12, v4
  v_lshlrev_b32 v4, 9, v4
  v_bfe_u32 v5, v0, 4, 1
  v_lshl_add_u32 v3, v5, 8, v3
  v_and_b32 v5, 7, v0
  v_lshl_add_u32 v3, v5, 4, v3
  v_lshrrev_b32 v160, 5, v0
  v_lshlrev_b32 v160, 6, v160
  v_bfe_u32 v5, v0, 4, 1
  v_lshl_add_u32 v160, v5, 5, v160
  v_and_b32 v5, 7, v0
  v_add_u32 v160, v160, v5
  s_lshl_b32 s31, s28, 7
  v_add_u32 v160, s31, v160
  v_lshlrev_b32 v160, 2, v160
  v_lshrrev_b32 v161, 3, v1
  v_lshlrev_b32 v161, 6, v161
  v_lshl_add_u32 v161, v2, 1, v161
  v_add_u32 v161, s31, v161
  v_lshlrev_b32 v161, 2, v161
  s_mul_i32 s31, s28, 3072
  v_lshlrev_b32 v162, 4, v0
  v_add_u32 v162, s31, v162
  s_mul_i32 s31, s28, 24
  v_add_u32 v164, s31, v0
  v_lshlrev_b32 v163, 4, v164
  v_lshrrev_b32 v6, 4, v164
  v_bfe_u32 v7, v164, 3, 1
  v_mad_u32_u24 v6, v7, 18, v6
  v_mul_u32_u24 v6, 2048, v6
  v_and_b32 v7, 7, v164
  v_lshl_add_u32 v164, v7, 4, v6
  s_mul_i32 s31, s59, 12288
  s_lshl_b32 s32, s47, 7
  s_add_u32 s31, s31, s32
  s_add_u32 s31, s31, 2359296
  s_mov_b64 s[80:81], s[26:27]
  s_add_u32 s80, s80, s31
  s_addc_u32 s81, s81, 0
  v_add_u32 v156, 2097152, v3
  v_add_u32 v157, 2097152, v4
  v_mov_b32 v158, v3
  v_mov_b32 v159, v4
  s_mov_b32 s49, 1048576
  v_mov_b32 v12, 0
L_own_lp_58:
  ds_read_b32 v13, v12 offset:16
  s_waitcnt lgkmcnt(0)
  v_readfirstlane_b32 s31, v13
  s_cmp_ge_u32 s31, 8
  s_cbranch_scc1 L_own_ok_59
  s_sub_u32 s49, s49, 1
  s_cbranch_scc1 L_own_ok_59
  s_sleep 4
  s_branch L_own_lp_58
L_own_ok_59:
  s_mov_b32 s49, 131072
  s_mov_b32 s63, 255
L_ha_lp_60:
  s_and_b32 s31, s49, 3
  s_cmp_eq_u32 s31, 1
  s_cselect_b64 vcc, -1, 0
  v_cndmask_b32_e32 v3, v156, v158, vcc
  v_cndmask_b32_e32 v4, v157, v159, vcc
  s_bitcmp1_b32 s63, 0
  s_cbranch_scc0 L_sk_62
  global_load_dwordx4 v[112:115], v3, s[36:37] offset:0 sc1
L_sk_62:
  s_bitcmp1_b32 s63, 1
  s_cbranch_scc0 L_sk_63
  global_load_dwordx4 v[116:119], v3, s[36:37] offset:1024 sc1
L_sk_63:
  s_bitcmp1_b32 s63, 2
  s_cbranch_scc0 L_sk_64
  global_load_dwordx4 v[120:123], v3, s[36:37] offset:2048 sc1
L_sk_64:
  s_bitcmp1_b32 s63, 3
  s_cbranch_scc0 L_sk_65
  global_load_dwordx4 v[124:127], v3, s[36:37] offset:3072 sc1
L_sk_65:
  s_bitcmp1_b32 s63, 4
  s_cbranch_scc0 L_sk_66
  global_load_dwordx4 v[128:131], v4, s[38:39] offset:0 sc1
L_sk_66:
  s_bitcmp1_b32 s63, 5
  s_cbranch_scc0 L_sk_67
  global_load_dwordx4 v[132:135], v4, s[38:39] offset:128 sc1
L_sk_67:
  s_bitcmp1_b32 s63, 6
  s_cbranch_scc0 L_sk_68
  global_load_dwordx4 v[136:139], v4, s[38:39] offset:256 sc1
L_sk_68:
  s_bitcmp1_b32 s63, 7
  s_cbranch_scc0 L_sk_69
  global_load_dwordx4 v[140:143], v4, s[38:39] offset:384 sc1
L_sk_69:
  s_waitcnt vmcnt(0)
  s_bitcmp1_b32 s63, 0
  s_cbranch_scc0 L_sk_70
  v_perm_b32 v5, v113, v112, s45
  v_perm_b32 v6, v115, v114, s46
  v_or_b32 v5, v5, v6
  v_cmp_eq_u32_e64 s[50:51], s40, v5
  s_cmp_eq_u64 s[50:51], -1
  s_cbranch_scc0 L_sk_70
  s_bitset0_b32 s63, 0
L_sk_70:
  s_bitcmp1_b32 s63, 1
  s_cbranch_scc0 L_sk_71
  v_perm_b32 v5, v117, v116, s45
  v_perm_b32 v6, v119, v118, s46
  v_or_b32 v5, v5, v6
  v_cmp_eq_u32_e64 s[50:51], s40, v5
  s_cmp_eq_u64 s[50:51], -1
  s_cbranch_scc0 L_sk_71
  s_bitset0_b32 s63, 1
L_sk_71:
  s_bitcmp1_b32 s63, 2
  s_cbranch_scc0 L_sk_72
  v_perm_b32 v5, v121, v120, s45
  v_perm_b32 v6, v123, v122, s46
  v_or_b32 v5, v5, v6
  v_cmp_eq_u32_e64 s[50:51], s40, v5
  s_cmp_eq_u64 s[50:51], -1
  s_cbranch_scc0 L_sk_72
  s_bitset0_b32 s63, 2
L_sk_72:
  s_bitcmp1_b32 s63, 3
  s_cbranch_scc0 L_sk_73
  v_perm_b32 v5, v125, v124, s45
  v_perm_b32 v6, v127, v126, s46
  v_or_b32 v5, v5, v6
  v_cmp_eq_u32_e64 s[50:51], s40, v5
  s_cmp_eq_u64 s[50:51], -1
  s_cbranch_scc0 L_sk_73
  s_bitset0_b32 s63, 3
L_sk_73:
  s_bitcmp1_b32 s63, 4
  s_cbranch_scc0 L_sk_74
  v_perm_b32 v5, v129, v128, s45
  v_perm_b32 v6, v131, v130, s46
  v_or_b32 v5, v5, v6
  v_cmp_eq_u32_e64 s[50:51], s40, v5
  s_cmp_eq_u64 s[50:51], -1
  s_cbranch_scc0 L_sk_74
  s_bitset0_b32 s63, 4
L_sk_74:
  s_bitcmp1_b32 s63, 5
  s_cbranch_scc0 L_sk_75
  v_perm_b32 v5, v133, v132, s45
  v_perm_b32 v6, v135, v134, s46
  v_or_b32 v5, v5, v6
  v_cmp_eq_u32_e64 s[50:51], s40, v5
  s_cmp_eq_u64 s[50:51], -1
  s_cbranch_scc0 L_sk_75
  s_bitset0_b32 s63, 5
L_sk_75:
  s_bitcmp1_b32 s63, 6
  s_cbranch_scc0 L_sk_76
  v_perm_b32 v5, v137, v136, s45
  v_perm_b32 v6, v139, v138, s46
  v_or_b32 v5, v5, v6
  v_cmp_eq_u32_e64 s[50:51], s40, v5
  s_cmp_eq_u64 s[50:51], -1
  s_cbranch_scc0 L_sk_76
  s_bitset0_b32 s63, 6
L_sk_76:
  s_bitcmp1_b32 s63, 7
  s_cbranch_scc0 L_sk_77
  v_perm_b32 v5, v141, v140, s45
  v_perm_b32 v6, v143, v142, s46
  v_or_b32 v5, v5, v6
  v_cmp_eq_u32_e64 s[50:51], s40, v5
  s_cmp_eq_u64 s[50:51], -1
  s_cbranch_scc0 L_sk_77
  s_bitset0_b32 s63, 7
L_sk_77:
  s_cmp_eq_u32 s63, 0
  s_cbranch_scc1 L_ha_ok_61
  s_sub_u32 s49, s49, 1
  s_cbranch_scc1 L_ha_ok_61
  s_branch L_ha_lp_60
L_ha_ok_61:
  v_and_b32 v128, 0xffffff00, v128
  v_and_b32 v132, 0xffffff00, v132
  v_and_b32 v136, 0xffffff00, v136
  v_and_b32 v140, 0xffffff00, v140
  v_max_f32 v144, v128, v132
  v_max3_f32 v144, v144, v136, v140
  v_and_b32 v129, 0xffffff00, v129
  v_and_b32 v133, 0xffffff00, v133
  v_and_b32 v137, 0xffffff00, v137
  v_and_b32 v141, 0xffffff00, v141
  v_max_f32_dpp v144, v144, v144 row_ror:8 row_mask:0xf bank_mask:0xf
  v_and_b32 v112, 0xffffff00, v112
  v_and_b32 v113, 0xffffff00, v113
  v_and_b32 v114, 0xffffff00, v114
  v_and_b32 v115, 0xffffff00, v115
  v_and_b32 v116, 0xffffff00, v116
  v_and_b32 v117, 0xffffff00, v117
  v_and_b32 v118, 0xffffff00, v118
  v_and_b32 v119, 0xffffff00, v119
  v_sub_f32 v128, v128, v144
  v_sub_f32 v132, v132, v144
  v_sub_f32 v136, v136, v144
  v_sub_f32 v140, v140, v144
  v_exp_f32 v128, v128
  v_exp_f32 v132, v132
  v_exp_f32 v136, v136
  v_exp_f32 v140, v140
  v_and_b32 v120, 0xffffff00, v120
  v_and_b32 v121, 0xffffff00, v121
  v_and_b32 v122, 0xffffff00, v122
  v_and_b32 v123, 0xffffff00, v123
  v_and_b32 v124, 0xffffff00, v124
  v_and_b32 v125, 0xffffff00, v125
  v_and_b32 v126, 0xffffff00, v126
  v_and_b32 v127, 0xffffff00, v127
  v_mul_f32 v145, v128, v129
  v_mul_f32 v148, v128, v112
  v_mul_f32 v149, v128, v113
  v_mul_f32 v150, v128, v114
  v_mul_f32 v151, v128, v115
  v_fmac_f32 v145, v132, v133
  v_fmac_f32 v148, v132, v116
  v_fmac_f32 v149, v132, v117
  v_fmac_f32 v150, v132, v118
  v_fmac_f32 v151, v132, v119
  v_fmac_f32 v145, v136, v137
  v_fmac_f32 v148, v136, v120
  v_fmac_f32 v149, v136, v121
  v_fmac_f32 v150, v136, v122
  v_fmac_f32 v151, v136, v123
  v_fmac_f32 v145, v140, v141
  v_fmac_f32 v148, v140, v124
  v_fmac_f32 v149, v140, v125
  v_fmac_f32 v150, v140, v126
  v_fmac_f32 v151, v140, v127
  s_nop 0
  v_add_f32_dpp v145, v145, v145 row_ror:8 row_mask:0xf bank_mask:0xf
  v_add_f32_dpp v148, v148, v148 row_ror:8 row_mask:0xf bank_mask:0xf
  v_add_f32_dpp v149, v149, v149 row_ror:8 row_mask:0xf bank_mask:0xf
  v_add_f32_dpp v150, v150, v150 row_ror:8 row_mask:0xf bank_mask:0xf
  v_add_f32_dpp v151, v151, v151 row_ror:8 row_mask:0xf bank_mask:0xf
  v_rcp_f32 v145, v145
  s_nop 0
  v_mul_f32 v148, v148, v145
  v_mul_f32 v149, v149, v145
  v_mul_f32 v150, v150, v145
  v_mul_f32 v151, v151, v145
  v_cvt_pk_bf16_f32 v148, v148, v148
  v_cvt_pk_bf16_f32 v149, v149, v149
  v_cvt_pk_bf16_f32 v150, v150, v150
  v_cvt_pk_bf16_f32 v151, v151, v151
  ds_write_b32 v160, v148 offset:18944
  ds_write_b32 v160, v149 offset:18976
  ds_write_b32 v160, v150 offset:19008
  ds_write_b32 v160, v151 offset:19040
  s_waitcnt lgkmcnt(0)
  ds_read_b64 v[112:113], v161 offset:18944
  ds_read_b64 v[114:115], v161 offset:18976
  ds_read_b64 v[116:117], v161 offset:19008
  ds_read_b64 v[118:119], v161 offset:19040
  ds_read_b64 v[120:121], v161 offset:19072
  ds_read_b64 v[122:123], v161 offset:19104
  ds_read_b64 v[124:125], v161 offset:19136
  ds_read_b64 v[126:127], v161 offset:19168
  s_waitcnt lgkmcnt(7)
  v_and_b32 v144, v112, v8
  v_and_b32 v145, v112, v9
  v_and_b32 v146, v112, v10
  v_and_b32 v147, v112, v11
  v_and_b32 v148, v113, v8
  v_and_b32 v149, v113, v9
  v_and_b32 v150, v113, v10
  v_and_b32 v151, v113, v11
  s_waitcnt lgkmcnt(6)
  s_nop 0
  v_mfma_f32_16x16x32_bf16 v[128:131], v[16:19], v[144:147], 0
  v_and_b32 v152, v114, v8
  v_and_b32 v153, v114, v9
  v_mfma_f32_16x16x32_bf16 v[132:135], v[20:23], v[144:147], 0
  v_and_b32 v154, v114, v10
  v_and_b32 v155, v114, v11
  v_mfma_f32_16x16x32_bf16 v[136:139], v[20:23], v[148:151], 0
  v_and_b32 v156, v115, v8
  v_and_b32 v157, v115, v9
  v_mfma_f32_16x16x32_bf16 v[140:143], v[24:27], v[148:151], 0
  v_and_b32 v158, v115, v10
  v_and_b32 v159, v115, v11
  s_waitcnt lgkmcnt(5)
  v_mfma_f32_16x16x32_bf16 v[128:131], v[28:31], v[152:155], v[128:131]
  v_and_b32 v144, v116, v8
  v_and_b32 v145, v116, v9
  v_mfma_f32_16x16x32_bf16 v[132:135], v[32:35], v[152:155], v[132:135]
  v_and_b32 v146, v116, v10
  v_and_b32 v147, v116, v11
  v_mfma_f32_16x16x32_bf16 v[136:139], v[32:35], v[156:159], v[136:139]
  v_and_b32 v148, v117, v8
  v_and_b32 v149, v117, v9
  v_mfma_f32_16x16x32_bf16 v[140:143], v[36:39], v[156:159], v[140:143]
  v_and_b32 v150, v117, v10
  v_and_b32 v151, v117, v11
  s_waitcnt lgkmcnt(4)
  v_mfma_f32_16x16x32_bf16 v[128:131], v[40:43], v[144:147], v[128:131]
  v_and_b32 v152, v118, v8
  v_and_b32 v153, v118, v9
  v_mfma_f32_16x16x32_bf16 v[132:135], v[44:47], v[144:147], v[132:135]
  v_and_b32 v154, v118, v10
  v_and_b32 v155, v118, v11
  v_mfma_f32_16x16x32_bf16 v[136:139], v[44:47], v[148:151], v[136:139]
  v_and_b32 v156, v119, v8
  v_and_b32 v157, v119, v9
  v_mfma_f32_16x16x32_bf16 v[140:143], v[48:51], v[148:151], v[140:143]
  v_and_b32 v158, v119, v10
  v_and_b32 v159, v119, v11
  s_waitcnt lgkmcnt(3)
  v_mfma_f32_16x16x32_bf16 v[128:131], v[52:55], v[152:155], v[128:131]
  v_and_b32 v144, v120, v8
  v_and_b32 v145, v120, v9
  v_mfma_f32_16x16x32_bf16 v[132:135], v[56:59], v[152:155], v[132:135]
  v_and_b32 v146, v120, v10
  v_and_b32 v147, v120, v11
  v_mfma_f32_16x16x32_bf16 v[136:139], v[56:59], v[156:159], v[136:139]
  v_and_b32 v148, v121, v8
  v_and_b32 v149, v121, v9
  v_mfma_f32_16x16x32_bf16 v[140:143], v[60:63], v[156:159], v[140:143]
  v_and_b32 v150, v121, v10
  v_and_b32 v151, v121, v11
  s_waitcnt lgkmcnt(2)
  v_mfma_f32_16x16x32_bf16 v[128:131], v[64:67], v[144:147], v[128:131]
  v_and_b32 v152, v122, v8
  v_and_b32 v153, v122, v9
  v_mfma_f32_16x16x32_bf16 v[132:135], v[68:71], v[144:147], v[132:135]
  v_and_b32 v154, v122, v10
  v_and_b32 v155, v122, v11
  v_mfma_f32_16x16x32_bf16 v[136:139], v[68:71], v[148:151], v[136:139]
  v_and_b32 v156, v123, v8
  v_and_b32 v157, v123, v9
  v_mfma_f32_16x16x32_bf16 v[140:143], v[72:75], v[148:151], v[140:143]
  v_and_b32 v158, v123, v10
  v_and_b32 v159, v123, v11
  s_waitcnt lgkmcnt(1)
  v_mfma_f32_16x16x32_bf16 v[128:131], v[76:79], v[152:155], v[128:131]
  v_and_b32 v144, v124, v8
  v_and_b32 v145, v124, v9
  v_mfma_f32_16x16x32_bf16 v[132:135], v[80:83], v[152:155], v[132:135]
  v_and_b32 v146, v124, v10
  v_and_b32 v147, v124, v11
  v_mfma_f32_16x16x32_bf16 v[136:139], v[80:83], v[156:159], v[136:139]
  v_and_b32 v148, v125, v8
  v_and_b32 v149, v125, v9
  v_mfma_f32_16x16x32_bf16 v[140:143], v[84:87], v[156:159], v[140:143]
  v_and_b32 v150, v125, v10
  v_and_b32 v151, v125, v11
  s_waitcnt lgkmcnt(0)
  v_mfma_f32_16x16x32_bf16 v[128:131], v[88:91], v[144:147], v[128:131]
  v_and_b32 v152, v126, v8
  v_and_b32 v153, v126, v9
  v_mfma_f32_16x16x32_bf16 v[132:135], v[92:95], v[144:147], v[132:135]
  v_and_b32 v154, v126, v10
  v_and_b32 v155, v126, v11
  v_mfma_f32_16x16x32_bf16 v[136:139], v[92:95], v[148:151], v[136:139]
  v_and_b32 v156, v127, v8
  v_and_b32 v157, v127, v9
  v_mfma_f32_16x16x32_bf16 v[140:143], v[96:99], v[148:151], v[140:143]
  v_and_b32 v158, v127, v10
  v_and_b32 v159, v127, v11
  v_mfma_f32_16x16x32_bf16 v[128:131], v[100:103], v[152:155], v[128:131]
  v_mfma_f32_16x16x32_bf16 v[132:135], v[104:107], v[152:155], v[132:135]
  v_mfma_f32_16x16x32_bf16 v[136:139], v[104:107], v[156:159], v[136:139]
  v_mfma_f32_16x16x32_bf16 v[140:143], v[108:111], v[156:159], v[140:143]
  v_cmp_gt_u32_e32 vcc, 2, v2
  v_mov_b32 v12, 0
  v_mov_b32 v13, 1
  s_nop 4
  ds_write_b128 v162, v[128:131] offset:21504
  v_cndmask_b32_e32 v132, v136, v132, vcc
  v_cndmask_b32_e32 v133, v137, v133, vcc
  v_cndmask_b32_e32 v134, v138, v134, vcc
  v_cndmask_b32_e32 v135, v139, v135, vcc
  ds_write_b128 v162, v[140:143] offset:23552
  ds_write_b128 v162, v[132:135] offset:22528
  s_mov_b64 s[52:53], exec
  s_waitcnt lgkmcnt(0)
  s_barrier
  s_mov_b64 exec, 0xffffff
  ds_read_b128 v[16:19], v163 offset:21504
  ds_read_b128 v[20:23], v163 offset:23040
  ds_read_b128 v[24:27], v163 offset:24576
  ds_read_b128 v[28:31], v163 offset:26112
  ds_read_b128 v[32:35], v163 offset:27648
  ds_read_b128 v[36:39], v163 offset:29184
  ds_read_b128 v[40:43], v163 offset:30720
  ds_read_b128 v[44:47], v163 offset:32256
  s_waitcnt lgkmcnt(6)
  v_add_f32 v16, v16, v20
  v_add_f32 v17, v17, v21
  v_add_f32 v18, v18, v22
  v_add_f32 v19, v19, v23
  s_waitcnt lgkmcnt(4)
  v_add_f32 v24, v24, v28
  v_add_f32 v16, v16, v24
  v_add_f32 v25, v25, v29
  v_add_f32 v17, v17, v25
  v_add_f32 v26, v26, v30
  v_add_f32 v18, v18, v26
  v_add_f32 v27, v27, v31
  v_add_f32 v19, v19, v27
  s_waitcnt lgkmcnt(2)
  v_add_f32 v32, v32, v36
  v_add_f32 v16, v16, v32
  v_add_f32 v33, v33, v37
  v_add_f32 v17, v17, v33
  v_add_f32 v34, v34, v38
  v_add_f32 v18, v18, v34
  v_add_f32 v35, v35, v39
  v_add_f32 v19, v19, v35
  s_waitcnt lgkmcnt(0)
  v_add_f32 v40, v40, v44
  v_add_f32 v16, v16, v40
  v_add_f32 v41, v41, v45
  v_add_f32 v17, v17, v41
  v_add_f32 v42, v42, v46
  v_add_f32 v18, v18, v42
  v_add_f32 v43, v43, v47
  v_add_f32 v19, v19, v43
  v_perm_b32 v20, v16, v14, s41
  v_perm_b32 v21, v17, v14, s42
  v_perm_b32 v22, v18, v14, s43
  v_perm_b32 v23, v19, v14, s44
  global_store_dwordx4 v164, v[20:23], s[80:81] sc1
  s_mov_b64 exec, s[52:53]
  s_branch L_end_stamp
L_attn:
  s_waitcnt lgkmcnt(0)
  s_lshl_b32 s31, s57, 4
  s_add_u32 s31, s31, s56
  s_lshl_b32 s31, s31, 20
  s_lshl_b32 s32, s58, 14
  s_add_u32 s31, s31, s32
  s_sub_u32 s32, s28, 4
  s_lshl_b32 s32, s32, 17
  s_add_u32 s31, s31, s32
  s_add_u32 s6, s6, s31
  s_addc_u32 s7, s7, 0
  s_add_u32 s8, s8, s31
  s_addc_u32 s9, s9, 0
  v_lshlrev_b32 v4, 8, v1
  v_lshl_add_u32 v4, v2, 4, v4
  v_lshlrev_b32 v3, 10, v2
  v_lshl_add_u32 v3, v1, 4, v3
  s_barrier
  s_setprio 2
  global_load_dwordx4 v[16:19], v4, s[6:7] offset:0 nt
  global_load_dwordx4 v[20:23], v4, s[6:7] offset:64 nt
  global_load_dwordx4 v[24:27], v4, s[6:7] offset:128 nt
  global_load_dwordx4 v[28:31], v4, s[6:7] offset:192 nt
  s_add_u32 s6, s6, 4096
  s_addc_u32 s7, s7, 0
  global_load_dwordx4 v[32:35], v4, s[6:7] offset:0 nt
  global_load_dwordx4 v[36:39], v4, s[6:7] offset:64 nt
  global_load_dwordx4 v[40:43], v4, s[6:7] offset:128 nt
  global_load_dwordx4 v[44:47], v4, s[6:7] offset:192 nt
  s_add_u32 s6, s6, 4096
  s_addc_u32 s7, s7, 0
  global_load_dwordx4 v[48:51], v4, s[6:7] offset:0 nt
  global_load_dwordx4 v[52:55], v4, s[6:7] offset:64 nt
  global_load_dwordx4 v[56:59], v4, s[6:7] offset:128 nt
  global_load_dwordx4 v[60:63], v4, s[6:7] offset:192 nt
  s_add_u32 s6, s6, 4096
  s_addc_u32 s7, s7, 0
  global_load_dwordx4 v[64:67], v4, s[6:7] offset:0 nt
  global_load_dwordx4 v[68:71], v4, s[6:7] offset:64 nt
  global_load_dwordx4 v[72:75], v4, s[6:7] offset:128 nt
  global_load_dwordx4 v[76:79], v4, s[6:7] offset:192 nt
  s_setprio 1
  s_cmp_ge_u32 s28, 8
  s_cbranch_scc1 L_grp2
  global_load_dwordx4 v[80:83], v3, s[8:9] offset:0 nt
  global_load_dwordx4 v[84:87], v3, s[8:9] offset:256 nt
  global_load_dwordx4 v[88:91], v3, s[8:9] offset:512 nt
  global_load_dwordx4 v[92:95], v3, s[8:9] offset:768 nt
  s_add_u32 s8, s8, 4096
  s_addc_u32 s9, s9, 0
  global_load_dwordx4 v[96:99], v3, s[8:9] offset:0 nt
  global_load_dwordx4 v[100:103], v3, s[8:9] offset:256 nt
  global_load_dwordx4 v[104:107], v3, s[8:9] offset:512 nt
  global_load_dwordx4 v[108:111], v3, s[8:9] offset:768 nt
  s_add_u32 s8, s8, 4096
  s_addc_u32 s9, s9, 0
  global_load_dwordx4 v[112:115], v3, s[8:9] offset:0 nt
  global_load_dwordx4 v[116:119], v3, s[8:9] offset:256 nt
  global_load_dwordx4 v[120:123], v3, s[8:9] offset:512 nt
  global_load_dwordx4 v[124:127], v3, s[8:9] offset:768 nt
  s_add_u32 s8, s8, 4096
  s_addc_u32 s9, s9, 0
  global_load_dwordx4 v[128:131], v3, s[8:9] offset:0 nt
  global_load_dwordx4 v[132:135], v3, s[8:9] offset:256 nt
  global_load_dwordx4 v[136:139], v3, s[8:9] offset:512 nt
  global_load_dwordx4 v[140:143], v3, s[8:9] offset:768 nt
  v_mov_b32 v4, 0
  v_mov_b32 v5, 1
  s_mov_b64 s[52:53], exec
  s_mov_b64 exec, 1
  ds_add_u32 v4, v5 offset:36
  s_mov_b64 exec, s[52:53]
  s_mov_b32 s49, 1048576
  v_mov_b32 v4, 0
L_qf_lp_78:
  ds_read_b32 v5, v4 offset:8
  s_waitcnt lgkmcnt(0)
  v_readfirstlane_b32 s31, v5
  s_cmp_ge_u32 s31, 1
  s_cbranch_scc1 L_qf_ok_79
  s_sub_u32 s49, s49, 1
  s_cbranch_scc1 L_qf_ok_79
  s_sleep 4
  s_branch L_qf_lp_78
L_qf_ok_79:
  v_lshrrev_b32 v4, 3, v1
  v_lshlrev_b32 v4, 8, v4
  v_lshl_add_u32 v4, v2, 4, v4
  ds_read_b128 v[144:147], v4 offset:9728
  ds_read_b128 v[148:151], v4 offset:9792
  ds_read_b128 v[152:155], v4 offset:9856
  ds_read_b128 v[156:159], v4 offset:9920
  v_mov_b32 v8, 0
  v_mov_b32 v9, 0
  v_mov_b32 v10, 0
  v_mov_b32 v11, 0
  v_mov_b32 v12, 0
  v_mov_b32 v13, 0
  v_mov_b32 v14, 0
  v_mov_b32 v15, 0
  v_mov_b32 v160, 0
  v_mov_b32 v161, 0
  v_mov_b32 v162, 0
  v_mov_b32 v163, 0
  v_mov_b32 v164, 0
  v_mov_b32 v165, 0
  v_mov_b32 v166, 0
  v_mov_b32 v167, 0
  s_waitcnt lgkmcnt(0)
  s_waitcnt vmcnt(28)
  v_mfma_f32_16x16x32_bf16 v[8:11], v[16:19], v[144:147], v[8:11]
  v_mfma_f32_16x16x32_bf16 v[8:11], v[20:23], v[148:151], v[8:11]
  v_mfma_f32_16x16x32_bf16 v[8:11], v[24:27], v[152:155], v[8:11]
  v_mfma_f32_16x16x32_bf16 v[8:11], v[28:31], v[156:159], v[8:11]
  s_waitcnt vmcnt(24)
  v_mfma_f32_16x16x32_bf16 v[12:15], v[32:35], v[144:147], v[12:15]
  v_mfma_f32_16x16x32_bf16 v[12:15], v[36:39], v[148:151], v[12:15]
  v_mfma_f32_16x16x32_bf16 v[12:15], v[40:43], v[152:155], v[12:15]
  v_mfma_f32_16x16x32_bf16 v[12:15], v[44:47], v[156:159], v[12:15]
  s_waitcnt vmcnt(20)
  v_mfma_f32_16x16x32_bf16 v[160:163], v[48:51], v[144:147], v[160:163]
  v_mfma_f32_16x16x32_bf16 v[160:163], v[52:55], v[148:151], v[160:163]
  v_mfma_f32_16x16x32_bf16 v[160:163], v[56:59], v[152:155], v[160:163]
  v_mfma_f32_16x16x32_bf16 v[160:163], v[60:63], v[156:159], v[160:163]
  s_waitcnt vmcnt(16)
  v_mfma_f32_16x16x32_bf16 v[164:167], v[64:67], v[144:147], v[164:167]
  v_mfma_f32_16x16x32_bf16 v[164:167], v[68:71], v[148:151], v[164:167]
  v_mfma_f32_16x16x32_bf16 v[164:167], v[72:75], v[152:155], v[164:167]
  v_mfma_f32_16x16x32_bf16 v[164:167], v[76:79], v[156:159], v[164:167]
  s_nop 7
  v_cvt_pk_bf16_f32 v144, v8, v9
  v_cvt_pk_bf16_f32 v145, v10, v11
  v_cvt_pk_bf16_f32 v146, v12, v13
  v_cvt_pk_bf16_f32 v147, v14, v15
  v_cvt_pk_bf16_f32 v148, v160, v161
  v_cvt_pk_bf16_f32 v149, v162, v163
  v_cvt_pk_bf16_f32 v150, v164, v165
  v_cvt_pk_bf16_f32 v151, v166, v167
  v_lshlrev_b32 v8, 16, v144
  v_and_b32 v9, 0xffff0000, v144
  v_lshlrev_b32 v10, 16, v145
  v_and_b32 v11, 0xffff0000, v145
  v_lshlrev_b32 v12, 16, v146
  v_and_b32 v13, 0xffff0000, v146
  v_lshlrev_b32 v14, 16, v147
  v_and_b32 v15, 0xffff0000, v147
  v_lshlrev_b32 v160, 16, v148
  v_and_b32 v161, 0xffff0000, v148
  v_lshlrev_b32 v162, 16, v149
  v_and_b32 v163, 0xffff0000, v149
  v_lshlrev_b32 v164, 16, v150
  v_and_b32 v165, 0xffff0000, v150
  v_lshlrev_b32 v166, 16, v151
  v_and_b32 v167, 0xffff0000, v151
  v_mul_f32 v8, 0x3db504f3, v8
  v_mul_f32 v9, 0x3db504f3, v9
  v_mul_f32 v10, 0x3db504f3, v10
  v_mul_f32 v11, 0x3db504f3, v11
  v_mul_f32 v12, 0x3db504f3, v12
  v_mul_f32 v13, 0x3db504f3, v13
  v_mul_f32 v14, 0x3db504f3, v14
  v_mul_f32 v15, 0x3db504f3, v15
  v_mul_f32 v160, 0x3db504f3, v160
  v_mul_f32 v161, 0x3db504f3, v161
  v_mul_f32 v162, 0x3db504f3, v162
  v_mul_f32 v163, 0x3db504f3, v163
  v_mul_f32 v164, 0x3db504f3, v164
  v_mul_f32 v165, 0x3db504f3, v165
  v_mul_f32 v166, 0x3db504f3, v166
  v_mul_f32 v167, 0x3db504f3, v167
  v_cvt_pk_bf16_f32 v144, v8, v9
  v_cvt_pk_bf16_f32 v145, v10, v11
  v_cvt_pk_bf16_f32 v146, v12, v13
  v_cvt_pk_bf16_f32 v147, v14, v15
  v_cvt_pk_bf16_f32 v148, v160, v161
  v_cvt_pk_bf16_f32 v149, v162, v163
  v_cvt_pk_bf16_f32 v150, v164, v165
  v_cvt_pk_bf16_f32 v151, v166, v167
  v_lshlrev_b32 v8, 16, v144
  v_and_b32 v9, 0xffff0000, v144
  v_lshlrev_b32 v10, 16, v145
  v_and_b32 v11, 0xffff0000, v145
  v_lshlrev_b32 v12, 16, v146
  v_and_b32 v13, 0xffff0000, v146
  v_lshlrev_b32 v14, 16, v147
  v_and_b32 v15, 0xffff0000, v147
  v_lshlrev_b32 v160, 16, v148
  v_and_b32 v161, 0xffff0000, v148
  v_lshlrev_b32 v162, 16, v149
  v_and_b32 v163, 0xffff0000, v149
  v_lshlrev_b32 v164, 16, v150
  v_and_b32 v165, 0xffff0000, v150
  v_lshlrev_b32 v166, 16, v151
  v_and_b32 v167, 0xffff0000, v151
  v_max3_f32 v152, v8, v9, v10
  v_max3_f32 v152, v152, v11, v12
  v_max3_f32 v152, v152, v13, v14
  v_max3_f32 v152, v152, v15, v160
  v_max3_f32 v152, v152, v161, v162
  v_max3_f32 v152, v152, v163, v164
  v_max3_f32 v152, v152, v165, v166
  v_max_f32 v152, v152, v167
  v_mov_b32 v153, v152
  s_nop 1
  v_permlane16_swap_b32 v152, v153
  s_nop 0
  v_max_f32 v152, v152, v153
  v_mov_b32 v153, v152
  s_nop 1
  v_permlane32_swap_b32 v152, v153
  s_nop 0
  v_max_f32 v152, v152, v153
  v_mul_f32 v152, s61, v152
  v_fma_f32 v8, v8, s61, -v152
  v_fma_f32 v9, v9, s61, -v152
  v_fma_f32 v10, v10, s61, -v152
  v_fma_f32 v11, v11, s61, -v152
  v_fma_f32 v12, v12, s61, -v152
  v_fma_f32 v13, v13, s61, -v152
  v_fma_f32 v14, v14, s61, -v152
  v_fma_f32 v15, v15, s61, -v152
  v_fma_f32 v160, v160, s61, -v152
  v_fma_f32 v161, v161, s61, -v152
  v_fma_f32 v162, v162, s61, -v152
  v_fma_f32 v163, v163, s61, -v152
  v_fma_f32 v164, v164, s61, -v152
  v_fma_f32 v165, v165, s61, -v152
  v_fma_f32 v166, v166, s61, -v152
  v_fma_f32 v167, v167, s61, -v152
  v_exp_f32 v8, v8
  v_exp_f32 v9, v9
  v_exp_f32 v10, v10
  v_exp_f32 v11, v11
  v_exp_f32 v12, v12
  v_exp_f32 v13, v13
  v_exp_f32 v14, v14
  v_exp_f32 v15, v15
  v_exp_f32 v160, v160
  v_exp_f32 v161, v161
  v_exp_f32 v162, v162
  v_exp_f32 v163, v163
  v_exp_f32 v164, v164
  v_exp_f32 v165, v165
  v_exp_f32 v166, v166
  v_exp_f32 v167, v167
  s_nop 0
  v_add_f32 v154, v8, v9
  v_add_f32 v154, v154, v10
  v_add_f32 v154, v154, v11
  v_add_f32 v154, v154, v12
  v_add_f32 v154, v154, v13
  v_add_f32 v154, v154, v14
  v_add_f32 v154, v154, v15
  v_add_f32 v154, v154, v160
  v_add_f32 v154, v154, v161
  v_add_f32 v154, v154, v162
  v_add_f32 v154, v154, v163
  v_add_f32 v154, v154, v164
  v_add_f32 v154, v154, v165
  v_add_f32 v154, v154, v166
  v_add_f32 v154, v154, v167
  v_cvt_pk_bf16_f32 v8, v8, v8
  v_cvt_pk_bf16_f32 v9, v9, v9
  v_cvt_pk_bf16_f32 v10, v10, v10
  v_cvt_pk_bf16_f32 v11, v11, v11
  v_cvt_pk_bf16_f32 v12, v12, v12
  v_cvt_pk_bf16_f32 v13, v13, v13
  v_cvt_pk_bf16_f32 v14, v14, v14
  v_cvt_pk_bf16_f32 v15, v15, v15
  v_cvt_pk_bf16_f32 v160, v160, v160
  v_cvt_pk_bf16_f32 v161, v161, v161
  v_cvt_pk_bf16_f32 v162, v162, v162
  v_cvt_pk_bf16_f32 v163, v163, v163
  v_cvt_pk_bf16_f32 v164, v164, v164
  v_cvt_pk_bf16_f32 v165, v165, v165
  v_cvt_pk_bf16_f32 v166, v166, v166
  v_cvt_pk_bf16_f32 v167, v167, v167
  v_mov_b32 v153, v154
  s_nop 1
  v_permlane16_swap_b32 v154, v153
  s_nop 0
  v_add_f32 v154, v154, v153
  v_mov_b32 v153, v154
  s_nop 1
  v_permlane32_swap_b32 v154, v153
  s_nop 0
  v_add_f32 v154, v154, v153
  v_and_b32 v4, 7, v1
  v_and_b32 v5, 1, v4
  v_lshrrev_b32 v4, 1, v4
  v_mov_b32 v6, 0xffff
  v_lshlrev_b32 v5, 4, v5
  v_lshlrev_b32 v5, v5, v6
  v_cmp_eq_u32_e32 vcc, 0, v4
  s_nop 1
  v_cndmask_b32_e32 v156, 0, v5, vcc
  v_cmp_eq_u32_e32 vcc, 1, v4
  s_nop 1
  v_cndmask_b32_e32 v157, 0, v5, vcc
  v_cmp_eq_u32_e32 vcc, 2, v4
  s_nop 1
  v_cndmask_b32_e32 v158, 0, v5, vcc
  v_cmp_eq_u32_e32 vcc, 3, v4
  s_nop 1
  v_cndmask_b32_e32 v159, 0, v5, vcc
  v_and_b32 v16, v8, v156
  v_and_b32 v17, v8, v157
  v_and_b32 v18, v8, v158
  v_and_b32 v19, v8, v159
  v_and_b32 v20, v9, v156
  v_and_b32 v21, v9, v157
  v_and_b32 v22, v9, v158
  v_and_b32 v23, v9, v159
  v_and_b32 v24, v10, v156
  v_and_b32 v25, v10, v157
  v_and_b32 v26, v10, v158
  v_and_b32 v27, v10, v159
  v_and_b32 v28, v11, v156
  v_and_b32 v29, v11, v157
  v_and_b32 v30, v11, v158
  v_and_b32 v31, v11, v159
  v_and_b32 v32, v12, v156
  v_and_b32 v33, v12, v157
  v_and_b32 v34, v12, v158
  v_and_b32 v35, v12, v159
  v_and_b32 v36, v13, v156
  v_and_b32 v37, v13, v157
  v_and_b32 v38, v13, v158
  v_and_b32 v39, v13, v159
  v_and_b32 v40, v14, v156
  v_and_b32 v41, v14, v157
  v_and_b32 v42, v14, v158
  v_and_b32 v43, v14, v159
  v_and_b32 v44, v15, v156
  v_and_b32 v45, v15, v157
  v_and_b32 v46, v15, v158
  v_and_b32 v47, v15, v159
  v_and_b32 v48, v160, v156
  v_and_b32 v49, v160, v157
  v_and_b32 v50, v160, v158
  v_and_b32 v51, v160, v159
  v_and_b32 v52, v161, v156
  v_and_b32 v53, v161, v157
  v_and_b32 v54, v161, v158
  v_and_b32 v55, v161, v159
  v_and_b32 v56, v162, v156
  v_and_b32 v57, v162, v157
  v_and_b32 v58, v162, v158
  v_and_b32 v59, v162, v159
  v_and_b32 v60, v163, v156
  v_and_b32 v61, v163, v157
  v_and_b32 v62, v163, v158
  v_and_b32 v63, v163, v159
  v_and_b32 v64, v164, v156
  v_and_b32 v65, v164, v157
  v_and_b32 v66, v164, v158
  v_and_b32 v67, v164, v159
  v_and_b32 v68, v165, v156
  v_and_b32 v69, v165, v157
  v_and_b32 v70, v165, v158
  v_and_b32 v71, v165, v159
  v_and_b32 v72, v166, v156
  v_and_b32 v73, v166, v157
  v_and_b32 v74, v166, v158
  v_and_b32 v75, v166, v159
  v_and_b32 v76, v167, v156
  v_and_b32 v77, v167, v157
  v_and_b32 v78, v167, v158
  v_and_b32 v79, v167, v159
  v_mov_b32 v144, 0
  v_mov_b32 v145, 0
  v_mov_b32 v146, 0
  v_mov_b32 v147, 0
  v_mov_b32 v148, 0
  v_mov_b32 v149, 0
  v_mov_b32 v150, 0
  v_mov_b32 v151, 0
  s_branch L_pv
L_grp2:
  s_mov_b32 s49, 1048576
  v_mov_b32 v4, 0
L_qf_lp_80:
  ds_read_b32 v5, v4 offset:8
  s_waitcnt lgkmcnt(0)
  v_readfirstlane_b32 s31, v5
  s_cmp_ge_u32 s31, 1
  s_cbranch_scc1 L_qf_ok_81
  s_sub_u32 s49, s49, 1
  s_cbranch_scc1 L_qf_ok_81
  s_sleep 4
  s_branch L_qf_lp_80
L_qf_ok_81:
  v_lshrrev_b32 v4, 3, v1
  v_lshlrev_b32 v4, 8, v4
  v_lshl_add_u32 v4, v2, 4, v4
  ds_read_b128 v[144:147], v4 offset:9728
  ds_read_b128 v[148:151], v4 offset:9792
  ds_read_b128 v[152:155], v4 offset:9856
  ds_read_b128 v[156:159], v4 offset:9920
  v_mov_b32 v8, 0
  v_mov_b32 v9, 0
  v_mov_b32 v10, 0
  v_mov_b32 v11, 0
  v_mov_b32 v12, 0
  v_mov_b32 v13, 0
  v_mov_b32 v14, 0
  v_mov_b32 v15, 0
  v_mov_b32 v160, 0
  v_mov_b32 v161, 0
  v_mov_b32 v162, 0
  v_mov_b32 v163, 0
  v_mov_b32 v164, 0
  v_mov_b32 v165, 0
  v_mov_b32 v166, 0
  v_mov_b32 v167, 0
  s_waitcnt lgkmcnt(0)
  s_waitcnt vmcnt(12)
  v_mfma_f32_16x16x32_bf16 v[8:11], v[16:19], v[144:147], v[8:11]
  v_mfma_f32_16x16x32_bf16 v[8:11], v[20:23], v[148:151], v[8:11]
  v_mfma_f32_16x16x32_bf16 v[8:11], v[24:27], v[152:155], v[8:11]
  v_mfma_f32_16x16x32_bf16 v[8:11], v[28:31], v[156:159], v[8:11]
  s_waitcnt vmcnt(8)
  v_mfma_f32_16x16x32_bf16 v[12:15], v[32:35], v[144:147], v[12:15]
  v_mfma_f32_16x16x32_bf16 v[12:15], v[36:39], v[148:151], v[12:15]
  v_mfma_f32_16x16x32_bf16 v[12:15], v[40:43], v[152:155], v[12:15]
  v_mfma_f32_16x16x32_bf16 v[12:15], v[44:47], v[156:159], v[12:15]
  s_waitcnt vmcnt(4)
  v_mfma_f32_16x16x32_bf16 v[160:163], v[48:51], v[144:147], v[160:163]
  v_mfma_f32_16x16x32_bf16 v[160:163], v[52:55], v[148:151], v[160:163]
  v_mfma_f32_16x16x32_bf16 v[160:163], v[56:59], v[152:155], v[160:163]
  v_mfma_f32_16x16x32_bf16 v[160:163], v[60:63], v[156:159], v[160:163]
  s_waitcnt vmcnt(0)
  v_mfma_f32_16x16x32_bf16 v[164:167], v[64:67], v[144:147], v[164:167]
  v_mfma_f32_16x16x32_bf16 v[164:167], v[68:71], v[148:151], v[164:167]
  v_mfma_f32_16x16x32_bf16 v[164:167], v[72:75], v[152:155], v[164:167]
  v_mfma_f32_16x16x32_bf16 v[164:167], v[76:79], v[156:159], v[164:167]
  s_nop 7
  v_cvt_pk_bf16_f32 v144, v8, v9
  v_cvt_pk_bf16_f32 v145, v10, v11
  v_cvt_pk_bf16_f32 v146, v12, v13
  v_cvt_pk_bf16_f32 v147, v14, v15
  v_cvt_pk_bf16_f32 v148, v160, v161
  v_cvt_pk_bf16_f32 v149, v162, v163
  v_cvt_pk_bf16_f32 v150, v164, v165
  v_cvt_pk_bf16_f32 v151, v166, v167
  v_lshlrev_b32 v8, 16, v144
  v_and_b32 v9, 0xffff0000, v144
  v_lshlrev_b32 v10, 16, v145
  v_and_b32 v11, 0xffff0000, v145
  v_lshlrev_b32 v12, 16, v146
  v_and_b32 v13, 0xffff0000, v146
  v_lshlrev_b32 v14, 16, v147
  v_and_b32 v15, 0xffff0000, v147
  v_lshlrev_b32 v160, 16, v148
  v_and_b32 v161, 0xffff0000, v148
  v_lshlrev_b32 v162, 16, v149
  v_and_b32 v163, 0xffff0000, v149
  v_lshlrev_b32 v164, 16, v150
  v_and_b32 v165, 0xffff0000, v150
  v_lshlrev_b32 v166, 16, v151
  v_and_b32 v167, 0xffff0000, v151
  v_mul_f32 v8, 0x3db504f3, v8
  v_mul_f32 v9, 0x3db504f3, v9
  v_mul_f32 v10, 0x3db504f3, v10
  v_mul_f32 v11, 0x3db504f3, v11
  v_mul_f32 v12, 0x3db504f3, v12
  v_mul_f32 v13, 0x3db504f3, v13
  v_mul_f32 v14, 0x3db504f3, v14
  v_mul_f32 v15, 0x3db504f3, v15
  v_mul_f32 v160, 0x3db504f3, v160
  v_mul_f32 v161, 0x3db504f3, v161
  v_mul_f32 v162, 0x3db504f3, v162
  v_mul_f32 v163, 0x3db504f3, v163
  v_mul_f32 v164, 0x3db504f3, v164
  v_mul_f32 v165, 0x3db504f3, v165
  v_mul_f32 v166, 0x3db504f3, v166
  v_mul_f32 v167, 0x3db504f3, v167
  v_cvt_pk_bf16_f32 v144, v8, v9
  v_cvt_pk_bf16_f32 v145, v10, v11
  v_cvt_pk_bf16_f32 v146, v12, v13
  v_cvt_pk_bf16_f32 v147, v14, v15
  v_cvt_pk_bf16_f32 v148, v160, v161
  v_cvt_pk_bf16_f32 v149, v162, v163
  v_cvt_pk_bf16_f32 v150, v164, v165
  v_cvt_pk_bf16_f32 v151, v166, v167
  v_lshlrev_b32 v8, 16, v144
  v_and_b32 v9, 0xffff0000, v144
  v_lshlrev_b32 v10, 16, v145
  v_and_b32 v11, 0xffff0000, v145
  v_lshlrev_b32 v12, 16, v146
  v_and_b32 v13, 0xffff0000, v146
  v_lshlrev_b32 v14, 16, v147
  v_and_b32 v15, 0xffff0000, v147
  v_lshlrev_b32 v160, 16, v148
  v_and_b32 v161, 0xffff0000, v148
  v_lshlrev_b32 v162, 16, v149
  v_and_b32 v163, 0xffff0000, v149
  v_lshlrev_b32 v164, 16, v150
  v_and_b32 v165, 0xffff0000, v150
  v_lshlrev_b32 v166, 16, v151
  v_and_b32 v167, 0xffff0000, v151
  v_max3_f32 v152, v8, v9, v10
  v_max3_f32 v152, v152, v11, v12
  v_max3_f32 v152, v152, v13, v14
  v_max3_f32 v152, v152, v15, v160
  v_max3_f32 v152, v152, v161, v162
  v_max3_f32 v152, v152, v163, v164
  v_max3_f32 v152, v152, v165, v166
  v_max_f32 v152, v152, v167
  v_mov_b32 v153, v152
  s_nop 1
  v_permlane16_swap_b32 v152, v153
  s_nop 0
  v_max_f32 v152, v152, v153
  v_mov_b32 v153, v152
  s_nop 1
  v_permlane32_swap_b32 v152, v153
  s_nop 0
  v_max_f32 v152, v152, v153
  v_mul_f32 v152, s61, v152
  v_fma_f32 v8, v8, s61, -v152
  v_fma_f32 v9, v9, s61, -v152
  v_fma_f32 v10, v10, s61, -v152
  v_fma_f32 v11, v11, s61, -v152
  v_fma_f32 v12, v12, s61, -v152
  v_fma_f32 v13, v13, s61, -v152
  v_fma_f32 v14, v14, s61, -v152
  v_fma_f32 v15, v15, s61, -v152
  v_fma_f32 v160, v160, s61, -v152
  v_fma_f32 v161, v161, s61, -v152
  v_fma_f32 v162, v162, s61, -v152
  v_fma_f32 v163, v163, s61, -v152
  v_fma_f32 v164, v164, s61, -v152
  v_fma_f32 v165, v165, s61, -v152
  v_fma_f32 v166, v166, s61, -v152
  v_fma_f32 v167, v167, s61, -v152
  v_exp_f32 v8, v8
  v_exp_f32 v9, v9
  v_exp_f32 v10, v10
  v_exp_f32 v11, v11
  v_exp_f32 v12, v12
  v_exp_f32 v13, v13
  v_exp_f32 v14, v14
  v_exp_f32 v15, v15
  v_exp_f32 v160, v160
  v_exp_f32 v161, v161
  v_exp_f32 v162, v162
  v_exp_f32 v163, v163
  v_exp_f32 v164, v164
  v_exp_f32 v165, v165
  v_exp_f32 v166, v166
  v_exp_f32 v167, v167
  s_nop 0
  v_add_f32 v154, v8, v9
  v_add_f32 v154, v154, v10
  v_add_f32 v154, v154, v11
  v_add_f32 v154, v154, v12
  v_add_f32 v154, v154, v13
  v_add_f32 v154, v154, v14
  v_add_f32 v154, v154, v15
  v_add_f32 v154, v154, v160
  v_add_f32 v154, v154, v161
  v_add_f32 v154, v154, v162
  v_add_f32 v154, v154, v163
  v_add_f32 v154, v154, v164
  v_add_f32 v154, v154, v165
  v_add_f32 v154, v154, v166
  v_add_f32 v154, v154, v167
  v_cvt_pk_bf16_f32 v8, v8, v8
  v_cvt_pk_bf16_f32 v9, v9, v9
  v_cvt_pk_bf16_f32 v10, v10, v10
  v_cvt_pk_bf16_f32 v11, v11, v11
  v_cvt_pk_bf16_f32 v12, v12, v12
  v_cvt_pk_bf16_f32 v13, v13, v13
  v_cvt_pk_bf16_f32 v14, v14, v14
  v_cvt_pk_bf16_f32 v15, v15, v15
  v_cvt_pk_bf16_f32 v160, v160, v160
  v_cvt_pk_bf16_f32 v161, v161, v161
  v_cvt_pk_bf16_f32 v162, v162, v162
  v_cvt_pk_bf16_f32 v163, v163, v163
  v_cvt_pk_bf16_f32 v164, v164, v164
  v_cvt_pk_bf16_f32 v165, v165, v165
  v_cvt_pk_bf16_f32 v166, v166, v166
  v_cvt_pk_bf16_f32 v167, v167, v167
  v_mov_b32 v153, v154
  s_nop 1
  v_permlane16_swap_b32 v154, v153
  s_nop 0
  v_add_f32 v154, v154, v153
  v_mov_b32 v153, v154
  s_nop 1
  v_permlane32_swap_b32 v154, v153
  s_nop 0
  v_add_f32 v154, v154, v153
  v_and_b32 v4, 7, v1
  v_and_b32 v5, 1, v4
  v_lshrrev_b32 v4, 1, v4
  v_mov_b32 v6, 0xffff
  v_lshlrev_b32 v5, 4, v5
  v_lshlrev_b32 v5, v5, v6
  v_cmp_eq_u32_e32 vcc, 0, v4
  s_nop 1
  v_cndmask_b32_e32 v156, 0, v5, vcc
  v_cmp_eq_u32_e32 vcc, 1, v4
  s_nop 1
  v_cndmask_b32_e32 v157, 0, v5, vcc
  v_cmp_eq_u32_e32 vcc, 2, v4
  s_nop 1
  v_cndmask_b32_e32 v158, 0, v5, vcc
  v_cmp_eq_u32_e32 vcc, 3, v4
  s_nop 1
  v_cndmask_b32_e32 v159, 0, v5, vcc
  v_and_b32 v16, v8, v156
  v_and_b32 v17, v8, v157
  v_and_b32 v18, v8, v158
  v_and_b32 v19, v8, v159
  v_and_b32 v20, v9, v156
  v_and_b32 v21, v9, v157
  v_and_b32 v22, v9, v158
  v_and_b32 v23, v9, v159
  v_and_b32 v24, v10, v156
  v_and_b32 v25, v10, v157
  v_and_b32 v26, v10, v158
  v_and_b32 v27, v10, v159
  v_and_b32 v28, v11, v156
  v_and_b32 v29, v11, v157
  v_and_b32 v30, v11, v158
  v_and_b32 v31, v11, v159
  v_and_b32 v32, v12, v156
  v_and_b32 v33, v12, v157
  v_and_b32 v34, v12, v158
  v_and_b32 v35, v12, v159
  v_and_b32 v36, v13, v156
  v_and_b32 v37, v13, v157
  v_and_b32 v38, v13, v158
  v_and_b32 v39, v13, v159
  v_and_b32 v40, v14, v156
  v_and_b32 v41, v14, v157
  v_and_b32 v42, v14, v158
  v_and_b32 v43, v14, v159
  v_and_b32 v44, v15, v156
  v_and_b32 v45, v15, v157
  v_and_b32 v46, v15, v158
  v_and_b32 v47, v15, v159
  v_and_b32 v48, v160, v156
  v_and_b32 v49, v160, v157
  v_and_b32 v50, v160, v158
  v_and_b32 v51, v160, v159
  v_and_b32 v52, v161, v156
  v_and_b32 v53, v161, v157
  v_and_b32 v54, v161, v158
  v_and_b32 v55, v161, v159
  v_and_b32 v56, v162, v156
  v_and_b32 v57, v162, v157
  v_and_b32 v58, v162, v158
  v_and_b32 v59, v162, v159
  v_and_b32 v60, v163, v156
  v_and_b32 v61, v163, v157
  v_and_b32 v62, v163, v158
  v_and_b32 v63, v163, v159
  v_and_b32 v64, v164, v156
  v_and_b32 v65, v164, v157
  v_and_b32 v66, v164, v158
  v_and_b32 v67, v164, v159
  v_and_b32 v68, v165, v156
  v_and_b32 v69, v165, v157
  v_and_b32 v70, v165, v158
  v_and_b32 v71, v165, v159
  v_and_b32 v72, v166, v156
  v_and_b32 v73, v166, v157
  v_and_b32 v74, v166, v158
  v_and_b32 v75, v166, v159
  v_and_b32 v76, v167, v156
  v_and_b32 v77, v167, v157
  v_and_b32 v78, v167, v158
  v_and_b32 v79, v167, v159
  v_mov_b32 v144, 0
  v_mov_b32 v145, 0
  v_mov_b32 v146, 0
  v_mov_b32 v147, 0
  v_mov_b32 v148, 0
  v_mov_b32 v149, 0
  v_mov_b32 v150, 0
  v_mov_b32 v151, 0
  global_load_dwordx4 v[80:83], v3, s[8:9] offset:0 nt
  global_load_dwordx4 v[84:87], v3, s[8:9] offset:256 nt
  global_load_dwordx4 v[88:91], v3, s[8:9] offset:512 nt
  global_load_dwordx4 v[92:95], v3, s[8:9] offset:768 nt
  s_add_u32 s8, s8, 4096
  s_addc_u32 s9, s9, 0
  global_load_dwordx4 v[96:99], v3, s[8:9] offset:0 nt
  global_load_dwordx4 v[100:103], v3, s[8:9] offset:256 nt
  global_load_dwordx4 v[104:107], v3, s[8:9] offset:512 nt
  global_load_dwordx4 v[108:111], v3, s[8:9] offset:768 nt
  s_add_u32 s8, s8, 4096
  s_addc_u32 s9, s9, 0
  global_load_dwordx4 v[112:115], v3, s[8:9] offset:0 nt
  global_load_dwordx4 v[116:119], v3, s[8:9] offset:256 nt
  global_load_dwordx4 v[120:123], v3, s[8:9] offset:512 nt
  global_load_dwordx4 v[124:127], v3, s[8:9] offset:768 nt
  s_add_u32 s8, s8, 4096
  s_addc_u32 s9, s9, 0
  global_load_dwordx4 v[128:131], v3, s[8:9] offset:0 nt
  global_load_dwordx4 v[132:135], v3, s[8:9] offset:256 nt
  global_load_dwordx4 v[136:139], v3, s[8:9] offset:512 nt
  global_load_dwordx4 v[140:143], v3, s[8:9] offset:768 nt
  v_mov_b32 v4, 0
  v_mov_b32 v5, 1
  s_mov_b64 s[52:53], exec
  s_mov_b64 exec, 1
  ds_add_u32 v4, v5 offset:36
  s_mov_b64 exec, s[52:53]
L_pv:
  s_sub_u32 s33, s28, 4
  s_lshl_b32 s31, s33, 10
  v_lshlrev_b32 v7, 4, v0
  v_add_u32 v4, s31, v7
  v_lshrrev_b32 v6, 3, v1
  v_lshlrev_b32 v6, 3, v6
  s_lshl_b32 s31, s33, 4
  v_add_u32 v5, s31, v6
  v_mov_b32 v12, 0
  ds_read_b32 v14, v12 offset:4
  v_mov_b32 v10, v152
  v_mov_b32 v11, v154
  ds_write_b64 v5, v[10:11] offset:10496
  s_lshl_b32 s31, s56, 1
  s_add_u32 s31, s31, s57
  s_lshl_b32 s31, s31, 3
  s_add_u32 s31, s31, s58
  s_lshl_b32 s32, s31, 10
  s_add_u32 s32, s32, 1048576
  s_mov_b64 s[36:37], s[26:27]
  s_add_u32 s36, s36, s32
  s_addc_u32 s37, s37, 0
  s_lshl_b32 s32, s31, 7
  s_add_u32 s32, s32, 1310720
  s_mov_b64 s[38:39], s[26:27]
  s_add_u32 s38, s38, s32
  s_addc_u32 s39, s39, 0
  v_mov_b32 v13, 1
  s_waitcnt vmcnt(12)
  v_mfma_f32_16x16x32_bf16 v[144:147], v[80:83], v[16:19], v[144:147]
  v_mfma_f32_16x16x32_bf16 v[148:151], v[84:87], v[20:23], v[148:151]
  v_mfma_f32_16x16x32_bf16 v[144:147], v[88:91], v[24:27], v[144:147]
  v_mfma_f32_16x16x32_bf16 v[148:151], v[92:95], v[28:31], v[148:151]
  s_waitcnt vmcnt(8)
  v_mfma_f32_16x16x32_bf16 v[144:147], v[96:99], v[32:35], v[144:147]
  v_mfma_f32_16x16x32_bf16 v[148:151], v[100:103], v[36:39], v[148:151]
  v_mfma_f32_16x16x32_bf16 v[144:147], v[104:107], v[40:43], v[144:147]
  v_mfma_f32_16x16x32_bf16 v[148:151], v[108:111], v[44:47], v[148:151]
  s_waitcnt vmcnt(4)
  v_mfma_f32_16x16x32_bf16 v[144:147], v[112:115], v[48:51], v[144:147]
  v_mfma_f32_16x16x32_bf16 v[148:151], v[116:119], v[52:55], v[148:151]
  v_mfma_f32_16x16x32_bf16 v[144:147], v[120:123], v[56:59], v[144:147]
  v_mfma_f32_16x16x32_bf16 v[148:151], v[124:127], v[60:63], v[148:151]
  s_waitcnt vmcnt(0)
  v_mfma_f32_16x16x32_bf16 v[144:147], v[128:131], v[64:67], v[144:147]
  v_mfma_f32_16x16x32_bf16 v[148:151], v[132:135], v[68:71], v[148:151]
  v_mfma_f32_16x16x32_bf16 v[144:147], v[136:139], v[72:75], v[144:147]
  v_mfma_f32_16x16x32_bf16 v[148:151], v[140:143], v[76:79], v[148:151]
  s_nop 7
  v_add_f32 v144, v144, v148
  v_add_f32 v145, v145, v149
  v_add_f32 v146, v146, v150
  v_add_f32 v147, v147, v151
  ds_write_b128 v4, v[144:147] offset:10752
  s_mov_b64 s[52:53], exec
  s_waitcnt lgkmcnt(0)
  s_mov_b64 exec, 1
  ds_add_rtn_u32 v13, v12, v13 offset:16
  s_waitcnt lgkmcnt(0)
  v_readfirstlane_b32 s31, v13
  s_mov_b64 exec, s[52:53]
  s_cmp_lg_u32 s31, 7
  s_cbranch_scc1 L_end_stamp
  ds_read_b64 v[16:17], v6 offset:10496
  ds_read_b64 v[18:19], v6 offset:10512
  ds_read_b64 v[20:21], v6 offset:10528
  ds_read_b64 v[22:23], v6 offset:10544
  ds_read_b64 v[24:25], v6 offset:10560
  ds_read_b64 v[26:27], v6 offset:10576
  ds_read_b64 v[28:29], v6 offset:10592
  ds_read_b64 v[30:31], v6 offset:10608
  ds_read_b128 v[32:35], v7 offset:10752
  ds_read_b128 v[36:39], v7 offset:11776
  ds_read_b128 v[40:43], v7 offset:12800
  ds_read_b128 v[44:47], v7 offset:13824
  ds_read_b128 v[48:51], v7 offset:14848
  ds_read_b128 v[52:55], v7 offset:15872
  ds_read_b128 v[56:59], v7 offset:16896
  ds_read_b128 v[60:63], v7 offset:17920
  s_waitcnt lgkmcnt(8)
  v_max3_f32 v8, v16, v18, v20
  v_max3_f32 v9, v22, v24, v26
  v_max3_f32 v8, v8, v28, v30
  v_max_f32 v8, v8, v9
  v_and_b32 v8, 0xffffff00, v8
  v_sub_f32 v16, v16, v8
  v_sub_f32 v18, v18, v8
  v_sub_f32 v20, v20, v8
  v_sub_f32 v22, v22, v8
  v_sub_f32 v24, v24, v8
  v_sub_f32 v26, v26, v8
  v_sub_f32 v28, v28, v8
  v_sub_f32 v30, v30, v8
  v_exp_f32 v16, v16
  v_exp_f32 v18, v18
  v_exp_f32 v20, v20
  v_exp_f32 v22, v22
  v_exp_f32 v24, v24
  v_exp_f32 v26, v26
  v_exp_f32 v28, v28
  v_exp_f32 v30, v30
  v_mov_b32 v10, 0
  v_mov_b32 v11, 0
  v_mul_f32 v9, v16, v17
  v_fmac_f32 v9, v18, v19
  v_fmac_f32 v9, v20, v21
  v_fmac_f32 v9, v22, v23
  v_fmac_f32 v9, v24, v25
  v_fmac_f32 v9, v26, v27
  v_fmac_f32 v9, v28, v29
  v_fmac_f32 v9, v30, v31
  s_waitcnt lgkmcnt(0)
  v_mul_f32 v64, v16, v32
  v_mul_f32 v65, v16, v33
  v_mul_f32 v66, v16, v34
  v_mul_f32 v67, v16, v35
  v_fmac_f32 v64, v18, v36
  v_fmac_f32 v65, v18, v37
  v_fmac_f32 v66, v18, v38
  v_fmac_f32 v67, v18, v39
  v_fmac_f32 v64, v20, v40
  v_fmac_f32 v65, v20, v41
  v_fmac_f32 v66, v20, v42
  v_fmac_f32 v67, v20, v43
  v_fmac_f32 v64, v22, v44
  v_fmac_f32 v65, v22, v45
  v_fmac_f32 v66, v22, v46
  v_fmac_f32 v67, v22, v47
  v_fmac_f32 v64, v24, v48
  v_fmac_f32 v65, v24, v49
  v_fmac_f32 v66, v24, v50
  v_fmac_f32 v67, v24, v51
  v_fmac_f32 v64, v26, v52
  v_fmac_f32 v65, v26, v53
  v_fmac_f32 v66, v26, v54
  v_fmac_f32 v67, v26, v55
  v_fmac_f32 v64, v28, v56
  v_fmac_f32 v65, v28, v57
  v_fmac_f32 v66, v28, v58
  v_fmac_f32 v67, v28, v59
  v_fmac_f32 v64, v30, v60
  v_fmac_f32 v65, v30, v61
  v_fmac_f32 v66, v30, v62
  v_fmac_f32 v67, v30, v63
  v_perm_b32 v68, v64, v14, s41
  v_perm_b32 v69, v65, v14, s42
  v_perm_b32 v70, v66, v14, s43
  v_perm_b32 v71, v67, v14, s44
  v_perm_b32 v72, v8, v14, s41
  v_perm_b32 v73, v9, v14, s42
  v_perm_b32 v74, v10, v14, s43
  v_perm_b32 v75, v11, v14, s44
  v_lshlrev_b32 v5, 1, v6
  v_and_b32 v4, 0x37, v0
  v_cmp_eq_u32_e32 vcc, 0, v4
  v_add_u32 v13, 2097152, v7
  v_add_u32 v12, 2097152, v5
  global_store_dwordx4 v13, v[68:71], s[36:37]
  s_and_saveexec_b64 s[52:53], vcc
  global_store_dwordx4 v12, v[72:75], s[38:39]
  global_store_dwordx4 v5, v[72:75], s[38:39] sc1
  s_mov_b64 exec, s[52:53]
  global_store_dwordx4 v7, v[68:71], s[36:37] sc1
L_end_stamp:
L_end:
  s_endpgm

.section .rodata,"a"
.p2align 6
.amdhsa_kernel parallel_sum__gqa_block_cached__swiglu_ffn__decode_kernel
  .amdhsa_next_free_vgpr 168
  .amdhsa_next_free_sgpr 102
  .amdhsa_accum_offset 168
  .amdhsa_group_segment_fixed_size 0
  .amdhsa_kernarg_size 96
  .amdhsa_user_sgpr_count 2
  .amdhsa_user_sgpr_kernarg_segment_ptr 1
  .amdhsa_system_sgpr_workgroup_id_x 1
.end_amdhsa_kernel
```
